```python
import torch

def _softmax(x, axis=-1):
    return torch.softmax(x, dim=axis)
def _gelu(x):
    return torch.nn.functional.gelu(x, approximate="tanh")
def _silu(x):
    return torch.nn.functional.silu(x)
def _sigmoid(x):
    return torch.sigmoid(x)
def _layernorm(x, axis=-1, eps=1e-5):
    m = x.mean(dim=axis, keepdim=True)
    v = x.var(dim=axis, keepdim=True, unbiased=False)
    return (x - m) / torch.sqrt(v + eps)
def _scatter_add(tgt, idx, src, axis=0):
    return tgt.clone().index_add_(axis, idx, src)
def _segment_sum(src, seg, n):
    out = torch.zeros((n,) + src.shape[1:], dtype=src.dtype)
    return out.index_add_(0, seg, src)
def _pad(x, pw):
    flat = tuple(v for pair in reversed(pw) for v in pair)
    return torch.nn.functional.pad(x, flat)

kernel_name = 'parallel_sum__sliding_block_cached__swiglu_ffn__decode'

def setup_inputs():

    _w = (lambda a: (lambda t: t.to(torch.bfloat16) if t.is_floating_point() else t)(torch.as_tensor(a)))
    def _A_setup():
        B, Sq, D = 1, 1, 1024
        Hq, Hkv, Sk, Dh = 32, 4, 32768, 128
        assert Hq % Hkv == 0, (Hq, Hkv)
        return {
            "x": _w((lambda *s: torch.randn(*s, dtype=torch.bfloat16) * 0.05)(B, Sq, D)),
            "k_cache": _w((lambda *s: torch.randn(*s, dtype=torch.bfloat16) * 3.2)(B, Hkv, Sk, Dh)),
            "v_cache": _w((lambda *s: torch.randn(*s, dtype=torch.bfloat16) * 1.6)(B, Hkv, Sk, Dh)),
            "wq": _w((lambda *s: torch.randn(*s, dtype=torch.bfloat16) * 3.2)(D, Hq * Dh) * (D ** -0.5)),
            "wo": _w((lambda *s: torch.randn(*s, dtype=torch.bfloat16) * 1.6)(Hq * Dh, D) * ((Hq * Dh) ** -0.5)),
        }
    _A_in = _A_setup()

    def _B_setup():
        B, S, D, F = 1, 1, 1024, 3584
        return {
            "x": _w((lambda *s: torch.randn(*s, dtype=torch.bfloat16) * 0.05)(B, S, D)),
            "w_gate": _w((lambda *s: torch.randn(*s, dtype=torch.bfloat16) * 0.05)(D, F)),
            "w_up": _w((lambda *s: torch.randn(*s, dtype=torch.bfloat16) * 0.05)(D, F)),
            "w_down": _w((lambda *s: torch.randn(*s, dtype=torch.bfloat16) * 0.05)(F, D)),
        }
    _B_in = _B_setup()

    return {
        "A_x": _A_in["x"],
        "A_k_cache": _A_in["k_cache"],
        "A_v_cache": _A_in["v_cache"],
        "A_wq": _A_in["wq"],
        "A_wo": _A_in["wo"],
        "B_x": _B_in["x"],
        "B_w_gate": _B_in["w_gate"],
        "B_w_up": _B_in["w_up"],
        "B_w_down": _B_in["w_down"],
    }

def reference(A_x, A_k_cache, A_v_cache, A_wq, A_wo, B_x, B_w_gate, B_w_up, B_w_down):
    def _A_ref(x, k_cache, v_cache, wq, wo):
        B, Sq, D = x.shape
        Hq, Dh = 32, 128
        Hkv, Sk = k_cache.shape[1], k_cache.shape[2]
        W = min(4096, max(256, Sk // 4))
        rep = Hq // Hkv
        q = (lambda x, *d: x.permute(*d))((x @ wq).reshape(B, Sq, Hq, Dh), 0, 2, 1, 3)
        k = (lambda x, n, axis: torch.repeat_interleave(x, n, dim=axis))(k_cache[:, :, Sk - W:, :], rep, axis=1)
        v = (lambda x, n, axis: torch.repeat_interleave(x, n, dim=axis))(v_cache[:, :, Sk - W:, :], rep, axis=1)
        scores = torch.einsum("bhqd,bhkd->bhqk", q, k) * (Dh ** -0.5)
        p = _softmax(scores, axis=-1)
        o = torch.einsum("bhqk,bhkd->bhqd", p, v)
        return (lambda x, *d: x.permute(*d))(o, 0, 2, 1, 3).reshape(B, Sq, Hq * Dh) @ wo

    def _B_ref(x, w_gate, w_up, w_down):
        g = _silu(x @ w_gate)
        u = x @ w_up
        return (g * u) @ w_down

    x = A_x
    xn = _layernorm(x, axis=-1)
    return x + _A_ref(xn, A_k_cache, A_v_cache, A_wq, A_wo) + _B_ref(xn, B_w_gate, B_w_up, B_w_down)
```

```asm
; @launch grid=(256,1,1) block=(256,1,1) lds=39424
.amdgcn_target "amdgcn-amd-amdhsa--gfx950"
.text
.globl parallel_sum__sliding_block_cached__swiglu_ffn__decode_kernel
.p2align 8
.type parallel_sum__sliding_block_cached__swiglu_ffn__decode_kernel,@function
parallel_sum__sliding_block_cached__swiglu_ffn__decode_kernel:
    s_cmp_ge_u32 s2, 256
    s_cbranch_scc1 L_end
    s_load_dwordx16 s[4:19], s[0:1], 0
    s_load_dwordx8 s[20:27], s[0:1], 64

    v_lshrrev_b32 v6, 6, v0
    v_and_b32 v1, 63, v0
    s_and_b32 s33, s2, 7
    v_readfirstlane_b32 s3, v6
    s_lshr_b32 s34, s2, 3
    s_getpc_b64 s[96:97]
L_pc:
    s_lshl_b32 s64, s34, 2
    s_add_u32 s64, s64, s3
    s_lshl_b32 s64, s64, 7
    s_min_u32 s64, s64, L_code_end - L_pc - 4
    v_mov_b32 v9, s64
    global_load_dword v14, v9, s[96:97]
    v_lshlrev_b32 v6, 4, v1
    v_lshrrev_b32 v7, 3, v1
    v_and_b32 v8, 7, v1
    s_lshr_b32 s65, s33, 1
    s_and_b32 s66, s33, 1
    s_lshl_b32 s66, s66, 5
    s_add_u32 s66, s66, s34
    s_and_b32 s67, s66, 15
    s_lshr_b32 s68, s66, 4
    s_lshl_b32 s69, s68, 8
    s_lshl_b32 s64, s3, 6
    s_add_u32 s69, s69, s64
    s_lshl_b32 s97, s69, 1
    v_lshlrev_b32 v9, 4, v7
    s_lshl_b32 s64, s69, 13
    s_lshl_b32 s96, s65, 11
    s_add_u32 s64, s64, s96
    s_lshl_b32 s96, s67, 7
    s_add_u32 s64, s64, s96
    v_lshlrev_b32 v16, 16, v7
    v_lshl_add_u32 v16, v8, 4, v16
    v_add_u32 v16, s64, v16
    v_lshrrev_b32 v32, 4, v1
    v_and_b32 v31, 15, v1
    s_mov_b32 s38, 2048
    s_mov_b32 s39, 0x20000
    s_mov_b32 s46, 8388608
    s_mov_b32 s47, 0x20000
    s_mov_b32 s64, 0
    s_waitcnt lgkmcnt(0)
    s_mov_b32 s36, s4
    s_mov_b32 s37, s5
    buffer_load_dwordx4 v[40:43], v6, s[36:39], 0 offen
    buffer_load_dwordx4 v[44:47], v6, s[36:39], 0 offen offset:1024
    buffer_load_dwordx4 v[48:51], v9, s[36:39], s97 offen
    s_load_dword s28, s[26:27], 0
    s_mov_b32 s44, s10
    s_mov_b32 s45, s11
    s_barrier

    buffer_load_dwordx4 v[152:155], v16, s[44:47], s64 offen nt
    s_add_u32 s64, s64, 8192
    buffer_load_dwordx4 v[156:159], v16, s[44:47], s64 offen nt
    s_add_u32 s64, s64, 8192
    buffer_load_dwordx4 v[160:163], v16, s[44:47], s64 offen nt
    s_add_u32 s64, s64, 8192
    buffer_load_dwordx4 v[164:167], v16, s[44:47], s64 offen nt
    s_add_u32 s64, s64, 8192
    buffer_load_dwordx4 v[168:171], v16, s[44:47], s64 offen nt
    s_add_u32 s64, s64, 8192
    buffer_load_dwordx4 v[172:175], v16, s[44:47], s64 offen nt
    s_add_u32 s64, s64, 8192
    buffer_load_dwordx4 v[176:179], v16, s[44:47], s64 offen nt
    s_add_u32 s64, s64, 8192
    buffer_load_dwordx4 v[180:183], v16, s[44:47], s64 offen nt
    v_bfe_u32 v52, v0, 1, 2
    v_and_b32 v53, 1, v0
    v_lshlrev_b32 v53, 4, v53
    v_mov_b32 v9, 0xffff
    v_lshlrev_b32 v9, v53, v9
    v_cmp_eq_u32 vcc, 0, v52
    v_cmp_eq_u32 s[96:97], 1, v52
    v_cmp_eq_u32 s[98:99], 2, v52
    v_cmp_eq_u32 s[100:101], 3, v52
    v_cndmask_b32 v2, 0, v9, vcc
    v_cndmask_b32 v3, 0, v9, s[96:97]
    v_cndmask_b32 v4, 0, v9, s[98:99]
    v_cndmask_b32 v5, 0, v9, s[100:101]
    s_lshl_b32 s63, s65, 23
    s_lshl_b32 s96, s66, 14
    s_add_u32 s63, s63, s96
    s_lshl_b32 s96, s3, 12
    s_add_u32 s63, s63, s96
    s_add_u32 s63, s63, 7340032
    s_lshl_b32 s96, s3, 12
    s_add_u32 s96, s96, 23040
    s_mov_b32 m0, s96
    v_lshlrev_b32 v17, 8, v31
    v_lshl_add_u32 v17, v32, 4, v17
    v_lshlrev_b32 v36, 8, v32
    v_lshl_add_u32 v36, v31, 4, v36

    s_mov_b32 s48, s6
    s_mov_b32 s49, s7
    s_mov_b32 s50, 33554432
    s_mov_b32 s51, 0x20000

    s_mov_b32 s52, s8
    s_mov_b32 s53, s9
    s_mov_b32 s54, 33554432
    s_mov_b32 s55, 0x20000

    s_mov_b32 s40, s26
    s_mov_b32 s41, s27
    s_mov_b32 s42, 268435456
    s_mov_b32 s43, 0x20000

    v_lshrrev_b32 v25, 2, v1
    v_xor_b32 v25, v25, v1
    v_and_b32 v25, 8, v25
    v_cmp_eq_u32 vcc, 0, v25
    v_lshlrev_b32 v25, 5, v8
    v_bfe_u32 v9, v1, 4, 1
    v_lshl_add_u32 v25, v9, 4, v25
    v_lshrrev_b32 v9, 5, v1
    v_lshl_add_u32 v25, v9, 8, v25
    s_lshl_b32 s64, s3, 9
    v_add_u32 v25, s64, v25
    v_add_u32 v9, 6144, v6
    v_cndmask_b32 v25, v9, v25, vcc
    v_lshlrev_b32 v13, 2, v0
    v_and_b32 v15, 3, v1
    v_lshlrev_b32 v10, 3, v15
    s_lshl_b32 s44, s65, 14
    s_add_u32 s44, s44, 4096
    s_lshl_b32 s45, s68, 12
    s_add_u32 s45, s45, s44
    s_lshl_b32 s96, s67, 8
    s_add_u32 s45, s45, s96

    s_waitcnt lgkmcnt(0)
    s_and_b32 s28, s28, 0x7f
    s_cmp_eq_u32 s28, 127
    s_cselect_b32 s28, 0, s28
    s_add_u32 s35, s28, 1
    s_add_u32 s29, s28, 33
    s_sub_u32 s64, s29, 127
    s_cmp_gt_u32 s29, 127
    s_cselect_b32 s29, s64, s29
    s_add_u32 s30, s28, 65
    s_sub_u32 s64, s30, 127
    s_cmp_gt_u32 s30, 127
    s_cselect_b32 s30, s64, s30
    s_add_u32 s31, s28, 97
    s_sub_u32 s64, s31, 127
    s_cmp_gt_u32 s31, 127
    s_cselect_b32 s31, s64, s31
    s_add_u32 s28, s28, 1
    s_lshl_b32 s32, s29, 8
    s_or_b32 s32, s32, s28
    s_lshl_b32 s64, s30, 16
    s_or_b32 s32, s32, s64
    s_lshl_b32 s64, s31, 24
    s_or_b32 s32, s32, s64
    s_movk_i32 s70, 0xff
    v_bfe_u32 v10, s32, v10, 8
    v_sub_u32 v11, 0x80, v10
    s_and_b32 s46, s32, 0xffff

    s_waitcnt vmcnt(9)
    buffer_load_dwordx4 v[184:187], v17, s[48:51], s63 offen offset:0 nt
    buffer_load_dwordx4 v[188:191], v17, s[48:51], s63 offen offset:64 nt
    v_lshlrev_b32 v52, 16, v40
    v_and_b32 v53, 0xffff0000, v40

    v_lshlrev_b32 v54, 16, v41
    v_and_b32 v55, 0xffff0000, v41

    v_lshlrev_b32 v56, 16, v42
    v_and_b32 v57, 0xffff0000, v42

    v_lshlrev_b32 v58, 16, v43
    v_and_b32 v59, 0xffff0000, v43

    v_lshlrev_b32 v60, 16, v44
    v_and_b32 v61, 0xffff0000, v44

    v_lshlrev_b32 v62, 16, v45
    v_and_b32 v63, 0xffff0000, v45

    v_lshlrev_b32 v64, 16, v46
    v_and_b32 v65, 0xffff0000, v46

    v_lshlrev_b32 v66, 16, v47
    v_and_b32 v67, 0xffff0000, v47

    v_readfirstlane_b32 s64, v52
    s_nop 1

    v_subrev_f32 v52, s64, v52
    v_subrev_f32 v53, s64, v53
    v_subrev_f32 v54, s64, v54
    v_subrev_f32 v55, s64, v55
    v_subrev_f32 v56, s64, v56
    v_subrev_f32 v57, s64, v57
    v_subrev_f32 v58, s64, v58
    v_subrev_f32 v59, s64, v59
    v_subrev_f32 v60, s64, v60
    v_subrev_f32 v61, s64, v61
    v_subrev_f32 v62, s64, v62
    v_subrev_f32 v63, s64, v63
    v_subrev_f32 v64, s64, v64
    v_subrev_f32 v65, s64, v65
    v_subrev_f32 v66, s64, v66
    v_subrev_f32 v67, s64, v67
    v_pk_add_f32 v[68:69], v[52:53], v[54:55]
    v_pk_mul_f32 v[70:71], v[52:53], v[52:53]

    v_pk_fma_f32 v[70:71], v[54:55], v[54:55], v[70:71]
    v_pk_fma_f32 v[70:71], v[56:57], v[56:57], v[70:71]
    v_pk_add_f32 v[68:69], v[68:69], v[56:57]
    v_pk_fma_f32 v[70:71], v[58:59], v[58:59], v[70:71]
    v_pk_add_f32 v[68:69], v[68:69], v[58:59]
    v_pk_fma_f32 v[70:71], v[60:61], v[60:61], v[70:71]
    v_pk_add_f32 v[68:69], v[68:69], v[60:61]
    v_pk_fma_f32 v[70:71], v[62:63], v[62:63], v[70:71]
    v_pk_add_f32 v[68:69], v[68:69], v[62:63]
    v_pk_fma_f32 v[70:71], v[64:65], v[64:65], v[70:71]
    v_pk_add_f32 v[68:69], v[68:69], v[64:65]
    v_pk_fma_f32 v[70:71], v[66:67], v[66:67], v[70:71]
    v_pk_add_f32 v[68:69], v[68:69], v[66:67]
    v_add_f32 v68, v68, v69
    v_add_f32 v70, v70, v71
    s_nop 0

    s_nop 0
    v_add_f32_dpp v68, v68, v68 row_ror:8 row_mask:0xf bank_mask:0xf
    v_add_f32_dpp v70, v70, v70 row_ror:8 row_mask:0xf bank_mask:0xf

    s_nop 0
    v_add_f32_dpp v68, v68, v68 row_ror:4 row_mask:0xf bank_mask:0xf
    v_add_f32_dpp v70, v70, v70 row_ror:4 row_mask:0xf bank_mask:0xf

    s_nop 0
    v_add_f32_dpp v68, v68, v68 row_ror:2 row_mask:0xf bank_mask:0xf
    v_add_f32_dpp v70, v70, v70 row_ror:2 row_mask:0xf bank_mask:0xf

    s_nop 0
    v_add_f32_dpp v68, v68, v68 row_ror:1 row_mask:0xf bank_mask:0xf
    v_add_f32_dpp v70, v70, v70 row_ror:1 row_mask:0xf bank_mask:0xf

    v_mov_b32 v69, v68
    v_mov_b32 v71, v70
    s_nop 0
    v_permlane16_swap_b32 v69, v68
    v_permlane16_swap_b32 v71, v70
    v_add_f32 v68, v68, v69
    v_add_f32 v70, v70, v71

    v_mov_b32 v69, v68
    v_mov_b32 v71, v70
    s_nop 0
    v_permlane32_swap_b32 v69, v68
    v_permlane32_swap_b32 v71, v70
    v_add_f32 v68, v68, v69
    v_add_f32 v70, v70, v71

    v_mul_f32 v68, 0x3a800000, v68
    v_mul_f32 v70, 0x3a800000, v70
    v_add_f32 v52, s64, v68
    v_fma_f32 v53, -v68, v68, v70
    v_max_f32 v53, 0, v53

    v_cvt_pk_bf16_f32 v52, v52, v52
    v_and_b32 v52, 0xffff0000, v52

    v_cvt_pk_bf16_f32 v53, v53, v53
    v_and_b32 v53, 0xffff0000, v53

    v_add_f32 v53, 0x3727c5ac, v53
    v_cvt_pk_bf16_f32 v53, v53, v53
    v_and_b32 v53, 0xffff0000, v53

    v_sqrt_f32 v55, v53
    s_waitcnt vmcnt(10)

    v_cvt_pk_bf16_f32 v55, v55, v55
    v_and_b32 v55, 0xffff0000, v55

    v_rcp_f32 v54, v55
    v_lshlrev_b32 v56, 16, v48
    v_and_b32 v57, 0xffff0000, v48

    v_lshlrev_b32 v58, 16, v49
    v_and_b32 v59, 0xffff0000, v49

    v_lshlrev_b32 v60, 16, v50
    v_and_b32 v61, 0xffff0000, v50

    v_lshlrev_b32 v62, 16, v51
    v_and_b32 v63, 0xffff0000, v51

    v_sub_f32 v56, v56, v52
    v_sub_f32 v57, v57, v52
    v_sub_f32 v58, v58, v52
    v_sub_f32 v59, v59, v52
    v_sub_f32 v60, v60, v52
    v_sub_f32 v61, v61, v52
    v_sub_f32 v62, v62, v52
    v_sub_f32 v63, v63, v52
    v_cvt_pk_bf16_f32 v48, v56, v57
    v_cvt_pk_bf16_f32 v49, v58, v59
    v_cvt_pk_bf16_f32 v50, v60, v61
    v_cvt_pk_bf16_f32 v51, v62, v63
    v_lshlrev_b32 v56, 16, v48
    v_and_b32 v57, 0xffff0000, v48

    v_lshlrev_b32 v58, 16, v49
    v_and_b32 v59, 0xffff0000, v49

    v_lshlrev_b32 v60, 16, v50
    v_and_b32 v61, 0xffff0000, v50

    v_lshlrev_b32 v62, 16, v51
    v_and_b32 v63, 0xffff0000, v51

    v_mul_f32 v64, v56, v54
    v_mul_f32 v65, v57, v54
    v_mul_f32 v66, v58, v54
    v_mul_f32 v67, v59, v54
    v_mul_f32 v68, v60, v54
    v_mul_f32 v69, v61, v54
    v_mul_f32 v70, v62, v54
    v_mul_f32 v71, v63, v54
    v_fma_f32 v56, -v64, v55, v56
    v_fma_f32 v57, -v65, v55, v57
    v_fma_f32 v58, -v66, v55, v58
    v_fma_f32 v59, -v67, v55, v59
    v_fma_f32 v60, -v68, v55, v60
    v_fma_f32 v61, -v69, v55, v61
    v_fma_f32 v62, -v70, v55, v62
    v_fma_f32 v63, -v71, v55, v63
    v_fmac_f32 v64, v56, v54
    v_fmac_f32 v65, v57, v54
    v_fmac_f32 v66, v58, v54
    v_fmac_f32 v67, v59, v54
    v_fmac_f32 v68, v60, v54
    v_fmac_f32 v69, v61, v54
    v_fmac_f32 v70, v62, v54
    v_fmac_f32 v71, v63, v54
    v_cvt_pk_bf16_f32 v64, v64, v64
    v_cvt_pk_bf16_f32 v65, v65, v65
    v_cvt_pk_bf16_f32 v66, v66, v66
    v_cvt_pk_bf16_f32 v67, v67, v67
    v_cvt_pk_bf16_f32 v68, v68, v68
    v_cvt_pk_bf16_f32 v69, v69, v69
    v_cvt_pk_bf16_f32 v70, v70, v70
    v_cvt_pk_bf16_f32 v71, v71, v71
    v_and_b32 v76, v64, v2
    v_and_b32 v77, v64, v3
    v_and_b32 v78, v64, v4
    v_and_b32 v79, v64, v5
    v_and_b32 v80, v65, v2
    v_and_b32 v81, v65, v3
    v_and_b32 v82, v65, v4
    v_and_b32 v83, v65, v5
    v_and_b32 v84, v66, v2
    v_and_b32 v85, v66, v3
    v_and_b32 v86, v66, v4
    v_and_b32 v87, v66, v5
    v_and_b32 v88, v67, v2
    v_and_b32 v89, v67, v3
    v_and_b32 v90, v67, v4
    v_and_b32 v91, v67, v5
    v_and_b32 v92, v68, v2
    v_and_b32 v93, v68, v3
    v_and_b32 v94, v68, v4
    v_and_b32 v95, v68, v5
    v_and_b32 v96, v69, v2
    v_and_b32 v97, v69, v3
    v_and_b32 v98, v69, v4
    v_and_b32 v99, v69, v5
    v_and_b32 v100, v70, v2
    v_and_b32 v101, v70, v3
    v_and_b32 v102, v70, v4
    v_and_b32 v103, v70, v5
    v_and_b32 v104, v71, v2
    v_and_b32 v105, v71, v3
    v_and_b32 v106, v71, v4
    v_and_b32 v107, v71, v5
    buffer_load_dwordx4 v[192:195], v17, s[48:51], s63 offen offset:128 nt
    buffer_load_dwordx4 v[196:199], v17, s[48:51], s63 offen offset:192 nt
    s_mov_b32 s56, s12
    s_mov_b32 s57, s13
    s_mov_b32 s58, 8388608
    s_mov_b32 s59, 0x20000

    s_mov_b32 s4, s16
    s_mov_b32 s5, s17
    s_mov_b32 s6, 7340032
    s_mov_b32 s7, 0x20000

    s_mov_b32 s8, s18
    s_mov_b32 s9, s19
    s_mov_b32 s10, 7340032
    s_mov_b32 s11, 0x20000

    s_mov_b32 s12, s20
    s_mov_b32 s13, s21
    s_mov_b32 s14, 7340032
    s_mov_b32 s15, 0x20000

    s_mov_b32 s16, s22
    s_mov_b32 s17, s23
    s_mov_b32 s18, 2048
    s_mov_b32 s19, 0x20000

    s_add_u32 s64, s67, 4
    s_lshr_b32 s64, s64, 3
    s_mul_i32 s60, s65, 14
    s_add_u32 s60, s60, s67
    s_sub_u32 s60, s60, s64
    s_add_u32 s61, s60, 28
    s_sub_u32 s64, s61, 56
    s_cmp_ge_u32 s61, 56
    s_cselect_b32 s61, s64, s61
    s_add_u32 s64, s34, 4
    s_lshr_b32 s64, s64, 3
    s_sub_u32 s62, s34, s64
    s_mul_i32 s64, s69, 7168
    v_mul_u32_u24 v27, 57344, v7
    v_lshl_add_u32 v27, v8, 4, v27
    s_lshl_b32 s96, s61, 7
    s_add_u32 s96, s96, s64
    v_add_u32 v28, s96, v27
    s_lshl_b32 s96, s60, 7
    s_add_u32 s96, s96, s64
    v_add_u32 v27, s96, v27
    s_lshl_b32 s60, s60, 11
    s_lshl_b32 s61, s61, 11
    s_add_u32 s61, s61, 1024
    s_cmp_eq_u32 s3, 0
    s_cselect_b32 s60, s60, s61
    s_lshl_b32 s64, s68, 8
    s_add_u32 s60, s60, s64
    s_add_u32 s60, s60, 1572864
    s_lshl_b32 s61, s62, 12
    s_lshr_b32 s64, s3, 1
    s_lshl_b32 s64, s64, 11
    s_add_u32 s61, s61, s64
    s_and_b32 s64, s3, 1
    s_lshl_b32 s64, s64, 7
    s_add_u32 s61, s61, s64
    s_add_u32 s61, s61, 1572864
    v_bfe_u32 v9, v1, 3, 1
    v_lshlrev_b32 v30, 8, v9
    v_lshl_add_u32 v30, v32, 5, v30
    v_lshl_add_u32 v30, v8, 2, v30
    s_lshl_b32 s64, s62, 18
    s_lshl_b32 s96, s3, 16
    s_add_u32 s64, s64, s96
    s_lshl_b32 s96, s33, 8
    s_add_u32 s64, s64, s96
    v_lshlrev_b32 v29, 14, v32
    v_lshl_add_u32 v29, v31, 4, v29
    v_add_u32 v29, s64, v29
    s_lshl_b32 s62, s33, 5
    s_add_u32 s62, s62, s34
    s_lshl_b32 s62, s62, 10
    s_add_u32 s62, s62, 2097152
    v_and_b32 v35, 511, v13
    s_lshr_b32 s64, s3, 1
    s_lshl_b32 s64, s64, 11
    v_add_u32 v35, s64, v35
    v_lshlrev_b32 v34, 2, v1
    v_mul_u32_u24 v22, 144, v8
    v_lshl_add_u32 v23, v32, 4, v22
    v_lshl_add_u32 v23, v9, 6, v23
    v_bfe_u32 v9, v1, 4, 1
    v_lshlrev_b32 v12, 5, v31
    v_lshl_add_u32 v12, v9, 4, v12
    s_lshl_b32 s64, s3, 9
    v_add_u32 v12, s64, v12
    s_lshl_b32 s67, s34, 2
    s_add_u32 s67, s67, s3
    s_lshr_b32 s64, s67, 5
    s_lshl_b32 s64, s64, 10
    s_bfe_u32 s96, s67, 0x20003
    s_lshl_b32 s96, s96, 5
    s_add_u32 s64, s64, s96
    s_and_b32 s96, s67, 1
    s_lshl_b32 s96, s96, 4
    s_add_u32 s64, s64, s96
    s_bfe_u32 s96, s67, 0x20001
    s_lshl_b32 s96, s96, 2
    s_add_u32 s64, s64, s96
    s_lshl_b32 s64, s64, 11
    s_lshl_b32 s96, s33, 8
    s_add_u32 s64, s64, s96
    v_lshlrev_b32 v18, 11, v32
    v_lshl_add_u32 v18, v31, 4, v18
    v_add_u32 v18, s64, v18
    s_lshl_b32 s69, s67, 7
    s_add_u32 s69, s69, 131072
    v_lshlrev_b32 v33, 5, v32
    v_lshl_add_u32 v33, v8, 2, v33
    v_mul_u32_u24 v21, 272, v8
    v_lshl_add_u32 v21, v32, 4, v21
    v_lshl_add_u32 v22, v32, 3, v22
    s_lshl_b32 s96, s3, 5
    v_add_u32 v22, s96, v22
    v_bfe_u32 v9, v1, 2, 2
    v_lshl_add_u32 v24, v32, 3, v9
    v_lshlrev_b32 v24, 8, v24
    v_lshlrev_b32 v9, 3, v15
    s_lshl_b32 s64, s3, 6
    v_add3_u32 v24, v24, v9, s64
    v_lshrrev_b32 v20, 5, v0
    v_and_b32 v9, 31, v0
    v_mul_u32_u24 v20, 272, v20
    v_lshl_add_u32 v20, v9, 3, v20
    s_lshl_b32 s97, s3, 10
    s_add_u32 s20, s44, s97
    s_lshl_b32 s22, s65, 18
    s_add_u32 s22, s22, 262144
    s_lshl_b32 s96, s66, 12
    s_add_u32 s23, s22, s96
    s_add_u32 s23, s23, s97
    s_mov_b32 s47, 0x03020302
    s_mov_b32 s24, 1035273459
    s_mov_b32 s25, 1069066811

    s_mov_b32 s26, 0x07060500
    s_mov_b32 s27, 0x07060501
    s_mov_b32 s66, 0x07060502
    s_mov_b32 s67, 0x07060503
    s_mov_b32 s68, 0x0c04000c
    s_lshl_b32 s21, s3, 11
    v_add_u32 v48, s21, v34

    s_waitcnt vmcnt(11)
    v_mfma_f32_16x16x32_bf16 v[124:127], v[76:79], v[152:155], 0
    s_waitcnt vmcnt(10)
    v_mfma_f32_16x16x32_bf16 v[124:127], v[80:83], v[156:159], v[124:127]
    s_waitcnt vmcnt(9)
    v_mfma_f32_16x16x32_bf16 v[124:127], v[84:87], v[160:163], v[124:127]
    s_waitcnt vmcnt(8)
    v_mfma_f32_16x16x32_bf16 v[124:127], v[88:91], v[164:167], v[124:127]
    s_waitcnt vmcnt(7)
    v_mfma_f32_16x16x32_bf16 v[124:127], v[92:95], v[168:171], v[124:127]
    s_waitcnt vmcnt(6)
    v_mfma_f32_16x16x32_bf16 v[124:127], v[96:99], v[172:175], v[124:127]
    buffer_load_dwordx4 v36, s[52:55], s63 offen offset:0 nt lds
    s_waitcnt vmcnt(6)
    v_mfma_f32_16x16x32_bf16 v[124:127], v[100:103], v[176:179], v[124:127]
    buffer_load_dwordx4 v36, s[52:55], s63 offen offset:1024 nt lds
    s_waitcnt vmcnt(6)
    v_mfma_f32_16x16x32_bf16 v[124:127], v[104:107], v[180:183], v[124:127]
    s_nop 7
    ds_write_b128 v25, v[124:127] offset:0
    s_waitcnt lgkmcnt(0)
    s_barrier
    s_cmp_lg_u32 s3, 0
    s_cbranch_scc1 L_nored

    ds_read2st64_b32 v[52:53], v34 offset0:0 offset1:1
    ds_read2st64_b32 v[54:55], v34 offset0:2 offset1:3
    ds_read2st64_b32 v[56:57], v34 offset0:4 offset1:5
    ds_read2st64_b32 v[58:59], v34 offset0:6 offset1:7
    s_waitcnt lgkmcnt(0)
    v_add_f32 v52, v52, v53
    v_add_f32 v54, v54, v55
    v_add_f32 v56, v56, v57
    v_add_f32 v58, v58, v59
    v_add_f32 v52, v52, v54
    v_add_f32 v56, v56, v58
    v_add_f32 v52, v52, v56
    v_add_u32 v52, v52, v11
    v_bfi_b32 v52, s70, v10, v52

    buffer_store_dword v52, v34, s[40:43], s45 offen sc1
L_nored:

    s_and_b32 s64, s34, 7
    s_cmp_eq_u32 s64, 3
    s_cbranch_scc1 L_light

    buffer_load_dwordx4 v36, s[52:55], s63 offen offset:2048 nt lds
    buffer_load_dwordx4 v36, s[52:55], s63 offen offset:3072 nt lds
    buffer_load_dwordx4 a[0:3], v27, s[4:7], 0 offen nt
    s_mov_b64 exec, 0
    s_cmp_eq_u32 s3, 0
    s_cbranch_scc1 HSEG0
    s_cmp_eq_u32 s3, 1
    s_cbranch_scc1 HSEG1
    s_cmp_eq_u32 s3, 2
    s_cbranch_scc1 HSEG2
    s_branch HSEG3
HW_ret:
    s_mov_b64 exec, -1

    s_cbranch_execz G_1
    s_waitcnt vmcnt(8)
G_1:
    s_cbranch_execz G_2
    s_waitcnt vmcnt(7)
G_2:
    s_cbranch_execz G_3
    s_waitcnt vmcnt(6)
G_3:
    s_cbranch_execz G_4
    s_waitcnt vmcnt(5)
G_4:
    s_cbranch_execz G_5
    s_waitcnt vmcnt(4)
    buffer_load_dwordx4 a[4:7], v28, s[8:11], 0 offen nt
G_5:
    s_cbranch_execz G_6
    s_waitcnt vmcnt(4)
    s_mov_b32 s99, 7168
    buffer_load_dwordx4 a[8:11], v27, s[4:7], s99 offen nt
G_6:
    s_cbranch_execz G_7
    s_waitcnt vmcnt(4)
    s_mov_b32 s99, 7168
    buffer_load_dwordx4 a[12:15], v28, s[8:11], s99 offen nt
G_7:
    s_cbranch_execz G_8
    s_waitcnt vmcnt(4)
    s_mov_b32 s99, 14336
    buffer_load_dwordx4 a[16:19], v27, s[4:7], s99 offen nt
G_8:
    s_barrier
    ds_read_b64_tr_b16 v[200:201], v24 offset:23040
    ds_read_b64_tr_b16 v[202:203], v24 offset:24064
    ds_read_b64_tr_b16 v[204:205], v24 offset:23072
    ds_read_b64_tr_b16 v[206:207], v24 offset:24096
    ds_read_b64_tr_b16 v[208:209], v24 offset:31232
    ds_read_b64_tr_b16 v[210:211], v24 offset:32256
    ds_read_b64_tr_b16 v[212:213], v24 offset:31264
    ds_read_b64_tr_b16 v[214:215], v24 offset:32288
    s_cbranch_execz G_9
    s_waitcnt vmcnt(4)
G_9:
    v_mfma_f32_16x16x32_bf16 v[144:147], v[76:79], a[0:3], 0
    s_cbranch_execz G_10
    s_mov_b32 s99, 14336
    buffer_load_dwordx4 a[20:23], v28, s[8:11], s99 offen nt
G_10:
    s_cbranch_execz G_11
    s_waitcnt vmcnt(4)
G_11:
    v_mfma_f32_16x16x32_bf16 v[148:151], v[76:79], a[4:7], 0
    s_cbranch_execz G_12
    buffer_load_dwordx4 v[216:219], v6, s[40:43], s20 offen sc1
    s_add_u32 s99, s20, 4096
    buffer_load_dwordx4 v[220:223], v6, s[40:43], s99 offen sc1
    s_add_u32 s99, s20, 8192
    buffer_load_dwordx4 v[224:227], v6, s[40:43], s99 offen sc1
    s_add_u32 s99, s20, 12288
    buffer_load_dwordx4 v[228:231], v6, s[40:43], s99 offen sc1
G_12:
    s_cbranch_execz G_13
    s_waitcnt vmcnt(7)
G_13:
    v_mfma_f32_16x16x32_bf16 v[144:147], v[80:83], a[8:11], v[144:147]
    s_cbranch_execz G_14
    s_mov_b32 s99, 21504
    buffer_load_dwordx4 a[24:27], v27, s[4:7], s99 offen nt
G_14:
    s_cbranch_execz G_15
    s_waitcnt vmcnt(7)
G_15:
    v_mfma_f32_16x16x32_bf16 v[148:151], v[80:83], a[12:15], v[148:151]
    s_cbranch_execz G_16
    s_mov_b32 s99, 21504
    buffer_load_dwordx4 a[28:31], v28, s[8:11], s99 offen nt
G_16:
    s_cbranch_execz G_17
    s_waitcnt vmcnt(7)
G_17:
    v_mfma_f32_16x16x32_bf16 v[144:147], v[84:87], a[16:19], v[144:147]
    s_cbranch_execz G_18
    s_mov_b32 s99, 28672
    buffer_load_dwordx4 a[32:35], v27, s[4:7], s99 offen nt
G_18:
    s_cbranch_execz G_19
    s_waitcnt vmcnt(7)
G_19:
    v_mfma_f32_16x16x32_bf16 v[148:151], v[84:87], a[20:23], v[148:151]
    s_cbranch_execz G_20
    s_mov_b32 s99, 28672
    buffer_load_dwordx4 a[36:39], v28, s[8:11], s99 offen nt
G_20:
HSEG0:
    v_mov_b32 v52, 0
    v_mov_b32 v53, 0

    s_cbranch_execz G_21
    s_waitcnt vmcnt(7)
G_21:
    v_msad_u8 v52, v216, s28, v52
    v_msad_u8 v53, v217, s29, v53
    v_msad_u8 v52, v218, s30, v52
    v_msad_u8 v53, v219, s31, v53
    s_cbranch_execz G_22
    s_waitcnt vmcnt(6)
G_22:
    v_msad_u8 v52, v220, s28, v52
    v_msad_u8 v53, v221, s29, v53
    v_msad_u8 v52, v222, s30, v52
    v_msad_u8 v53, v223, s31, v53
    s_cbranch_execz G_23
    s_waitcnt vmcnt(5)
G_23:
    v_msad_u8 v52, v224, s28, v52
    v_msad_u8 v53, v225, s29, v53
    v_msad_u8 v52, v226, s30, v52
    v_msad_u8 v53, v227, s31, v53
    s_cbranch_execz G_24
    s_waitcnt vmcnt(4)
G_24:
    v_msad_u8 v52, v228, s28, v52
    v_msad_u8 v53, v229, s29, v53
    v_msad_u8 v52, v230, s30, v52
    v_msad_u8 v53, v231, s31, v53
    v_or_b32 v52, v52, v53
    v_cmp_ne_u32 vcc, 0, v52

    s_nop 1
    s_cbranch_vccz Hrq_ok
    s_mov_b32 s71, 1048576
Hrq:

    buffer_load_dwordx4 v[216:219], v6, s[40:43], s20 offen sc1
    s_add_u32 s99, s20, 4096
    buffer_load_dwordx4 v[220:223], v6, s[40:43], s99 offen sc1
    s_add_u32 s99, s20, 8192
    buffer_load_dwordx4 v[224:227], v6, s[40:43], s99 offen sc1
    s_add_u32 s99, s20, 12288
    buffer_load_dwordx4 v[228:231], v6, s[40:43], s99 offen sc1
    s_waitcnt vmcnt(0)
    v_mov_b32 v52, 0
    v_mov_b32 v53, 0

    v_msad_u8 v52, v216, s28, v52
    v_msad_u8 v53, v217, s29, v53
    v_msad_u8 v52, v218, s30, v52
    v_msad_u8 v53, v219, s31, v53
    v_msad_u8 v52, v220, s28, v52
    v_msad_u8 v53, v221, s29, v53
    v_msad_u8 v52, v222, s30, v52
    v_msad_u8 v53, v223, s31, v53
    v_msad_u8 v52, v224, s28, v52
    v_msad_u8 v53, v225, s29, v53
    v_msad_u8 v52, v226, s30, v52
    v_msad_u8 v53, v227, s31, v53
    v_msad_u8 v52, v228, s28, v52
    v_msad_u8 v53, v229, s29, v53
    v_msad_u8 v52, v230, s30, v52
    v_msad_u8 v53, v231, s31, v53
    v_or_b32 v52, v52, v53
    v_cmp_ne_u32 vcc, 0, v52

    s_sub_u32 s71, s71, 1
    s_cmp_eq_u32 s71, 0
    s_cbranch_scc1 Hrq_ok
    s_cbranch_vccnz Hrq
Hrq_ok:

    v_pk_add_f32 v[56:57], v[216:217], v[220:221]
    v_pk_add_f32 v[58:59], v[218:219], v[222:223]
    v_pk_add_f32 v[60:61], v[224:225], v[228:229]
    v_pk_add_f32 v[62:63], v[226:227], v[230:231]
    v_pk_add_f32 v[56:57], v[56:57], v[60:61]
    v_pk_add_f32 v[58:59], v[58:59], v[62:63]
    v_cvt_pk_bf16_f32 v56, v56, v57
    v_cvt_pk_bf16_f32 v57, v58, v59
    ds_write_b64 v20, v[56:57] offset:11264

    s_cbranch_execz G_26
    s_mov_b32 s99, 35840
    buffer_load_dwordx4 a[40:43], v27, s[4:7], s99 offen nt
G_26:
    s_waitcnt lgkmcnt(0)
    s_cbranch_execz G_27
    s_barrier
G_27:
    ds_read_b128 v[108:111], v21 offset:11264
    ds_read_b128 v[112:115], v21 offset:11328
    ds_read_b128 v[116:119], v21 offset:11392
    ds_read_b128 v[120:123], v21 offset:11456

    s_cbranch_execz G_28
    s_mov_b32 s99, 35840
    buffer_load_dwordx4 a[44:47], v28, s[8:11], s99 offen nt
    s_mov_b32 s99, 43008
    buffer_load_dwordx4 a[48:51], v27, s[4:7], s99 offen nt
G_28:
    s_waitcnt lgkmcnt(3)
    v_mfma_f32_16x16x32_bf16 v[124:127], v[184:187], v[108:111], 0
    s_waitcnt lgkmcnt(2)
    v_mfma_f32_16x16x32_bf16 v[124:127], v[188:191], v[112:115], v[124:127]
    s_waitcnt lgkmcnt(1)
    v_mfma_f32_16x16x32_bf16 v[124:127], v[192:195], v[116:119], v[124:127]
    s_waitcnt lgkmcnt(0)
    v_mfma_f32_16x16x32_bf16 v[124:127], v[196:199], v[120:123], v[124:127]
    s_nop 7
    v_cvt_pk_bf16_f32 v52, v124, v125
    v_cvt_pk_bf16_f32 v53, v126, v127
    v_lshlrev_b32 v56, 16, v52
    v_and_b32 v57, 0xffff0000, v52
    v_lshlrev_b32 v58, 16, v53
    v_and_b32 v59, 0xffff0000, v53
    v_mul_f32 v56, s24, v56
    v_mul_f32 v57, s24, v57
    v_mul_f32 v58, s24, v58
    v_mul_f32 v59, s24, v59
    v_cvt_pk_bf16_f32 v52, v56, v57
    v_cvt_pk_bf16_f32 v53, v58, v59
    ds_write_b64 v22, v[52:53] offset:13440
    s_waitcnt lgkmcnt(0)

    s_cbranch_execz HW_ret
    s_barrier
HSEG1:
    ds_read_b128 v[52:55], v23 offset:13440

    s_cbranch_execz G_29
    s_mov_b32 s99, 43008
    buffer_load_dwordx4 a[52:55], v28, s[8:11], s99 offen nt
    s_mov_b32 s99, 50176
    buffer_load_dwordx4 a[56:59], v27, s[4:7], s99 offen nt
G_29:
    s_waitcnt lgkmcnt(0)
    v_lshlrev_b32 v56, 16, v52
    v_and_b32 v57, 0xffff0000, v52

    v_lshlrev_b32 v58, 16, v53
    v_and_b32 v59, 0xffff0000, v53

    v_lshlrev_b32 v60, 16, v54
    v_and_b32 v61, 0xffff0000, v54

    v_lshlrev_b32 v62, 16, v55
    v_and_b32 v63, 0xffff0000, v55

    v_max3_f32 v64, v56, v57, v58
    v_max3_f32 v65, v59, v60, v61
    v_max3_f32 v64, v62, v63, v64
    v_max_f32 v64, v64, v65

    s_nop 1
    v_max_f32_dpp v64, v64, v64 row_ror:8 row_mask:0xf bank_mask:0xf

    v_mov_b32 v65, v64
    s_nop 1
    v_permlane16_swap_b32 v65, v64
    v_max_f32 v64, v64, v65

    v_mov_b32 v65, v64
    s_nop 1
    v_permlane32_swap_b32 v65, v64
    v_max_f32 v64, v64, v65

    v_mul_f32 v64, s25, v64
    v_fma_f32 v56, v56, s25, -v64
    v_fma_f32 v57, v57, s25, -v64
    v_fma_f32 v58, v58, s25, -v64
    v_fma_f32 v59, v59, s25, -v64
    v_fma_f32 v60, v60, s25, -v64
    v_fma_f32 v61, v61, s25, -v64
    v_fma_f32 v62, v62, s25, -v64
    v_fma_f32 v63, v63, s25, -v64
    v_exp_f32 v56, v56
    v_exp_f32 v57, v57
    v_exp_f32 v58, v58
    v_exp_f32 v59, v59
    v_exp_f32 v60, v60
    v_exp_f32 v61, v61
    v_exp_f32 v62, v62
    v_exp_f32 v63, v63
    v_cvt_pk_bf16_f32 v72, v56, v57
    v_cvt_pk_bf16_f32 v73, v58, v59
    v_cvt_pk_bf16_f32 v74, v60, v61
    v_cvt_pk_bf16_f32 v75, v62, v63
    v_pk_add_f32 v[52:53], v[56:57], v[58:59]
    v_pk_add_f32 v[54:55], v[60:61], v[62:63]

    v_mfma_f32_16x16x32_bf16 v[128:131], v[200:203], v[72:75], 0
    v_mfma_f32_16x16x32_bf16 v[136:139], v[208:211], v[72:75], 0
    v_mfma_f32_16x16x32_bf16 v[132:135], v[204:207], v[72:75], 0
    v_mfma_f32_16x16x32_bf16 v[140:143], v[212:215], v[72:75], 0
    s_cbranch_execz G_30
    s_mov_b32 s99, 50176
    buffer_load_dwordx4 a[60:63], v28, s[8:11], s99 offen nt
G_30:
    v_pk_add_f32 v[52:53], v[52:53], v[54:55]
    v_add_f32 v66, v52, v53

    s_nop 1
    v_add_f32_dpp v66, v66, v66 row_ror:8 row_mask:0xf bank_mask:0xf

    v_mov_b32 v65, v66
    s_nop 1
    v_permlane16_swap_b32 v65, v66
    v_add_f32 v66, v66, v65

    v_mov_b32 v65, v66
    s_nop 1
    v_permlane32_swap_b32 v65, v66
    v_add_f32 v66, v66, v65

    v_log_f32 v67, v66
    v_rcp_f32 v68, v66

    v_add_f32_dpp v124, v136, v128 row_ror:8 row_mask:0xf bank_mask:0x3
    v_add_f32_dpp v125, v137, v129 row_ror:8 row_mask:0xf bank_mask:0x3
    v_add_f32_dpp v126, v138, v130 row_ror:8 row_mask:0xf bank_mask:0x3
    v_add_f32_dpp v127, v139, v131 row_ror:8 row_mask:0xf bank_mask:0x3
    v_add_f32 v67, v67, v64
    v_add_f32_dpp v124, v132, v140 row_ror:8 row_mask:0xf bank_mask:0xc
    v_add_f32_dpp v125, v133, v141 row_ror:8 row_mask:0xf bank_mask:0xc
    v_add_f32_dpp v126, v134, v142 row_ror:8 row_mask:0xf bank_mask:0xc
    v_add_f32_dpp v127, v135, v143 row_ror:8 row_mask:0xf bank_mask:0xc
    v_add_u32 v67, 0x80, v67
    v_bfi_b32 v67, s70, v10, v67

    v_mul_f32 v124, v124, v68
    v_mul_f32 v125, v125, v68
    v_mul_f32 v126, v126, v68
    v_mul_f32 v127, v127, v68
    v_perm_b32 v124, v124, v67, s26
    v_perm_b32 v125, v125, v67, s27
    v_perm_b32 v126, v126, v67, s66
    v_perm_b32 v127, v127, v67, s67
    s_cbranch_execz HW_ret
    buffer_store_dwordx4 v[124:127], v6, s[40:43], s23 offen sc1
    buffer_load_dwordx4 v[152:155], v18, s[56:59], 0 offen nt
    s_cbranch_execz G_31
    s_waitcnt vmcnt(11)
G_31:
    v_mfma_f32_16x16x32_bf16 v[144:147], v[88:91], a[24:27], v[144:147]
    s_cbranch_execz G_33
    s_waitcnt vmcnt(10)
G_33:
    v_mfma_f32_16x16x32_bf16 v[148:151], v[88:91], a[28:31], v[148:151]
    s_cbranch_execz G_35
    s_waitcnt vmcnt(9)
G_35:
    v_mfma_f32_16x16x32_bf16 v[144:147], v[92:95], a[32:35], v[144:147]
    s_cbranch_execz G_37
    s_waitcnt vmcnt(8)
G_37:
    v_mfma_f32_16x16x32_bf16 v[148:151], v[92:95], a[36:39], v[148:151]
    s_cbranch_execz G_39
    s_waitcnt vmcnt(7)
G_39:
    v_mfma_f32_16x16x32_bf16 v[144:147], v[96:99], a[40:43], v[144:147]
    s_cbranch_execz G_41
    s_waitcnt vmcnt(6)
G_41:
    v_mfma_f32_16x16x32_bf16 v[148:151], v[96:99], a[44:47], v[148:151]
    s_cbranch_execz G_43
    s_waitcnt vmcnt(5)
G_43:
    v_mfma_f32_16x16x32_bf16 v[144:147], v[100:103], a[48:51], v[144:147]
    s_cbranch_execz G_45
    s_waitcnt vmcnt(4)
G_45:
    v_mfma_f32_16x16x32_bf16 v[148:151], v[100:103], a[52:55], v[148:151]
    s_cbranch_execz G_46
    s_mov_b32 s99, 262144
    buffer_load_dwordx4 v[156:159], v18, s[56:59], s99 offen nt
G_46:
    s_cbranch_execz G_47
    s_waitcnt vmcnt(4)
G_47:
    v_mfma_f32_16x16x32_bf16 v[144:147], v[104:107], a[56:59], v[144:147]
    s_cbranch_execz G_48
    s_mov_b32 s99, 524288
    buffer_load_dwordx4 v[160:163], v18, s[56:59], s99 offen nt
G_48:
    s_cbranch_execz G_49
    s_waitcnt vmcnt(4)
G_49:
    v_mfma_f32_16x16x32_bf16 v[148:151], v[104:107], a[60:63], v[148:151]
    s_cbranch_execz G_50
    s_mov_b32 s99, 786432
    buffer_load_dwordx4 v[164:167], v18, s[56:59], s99 offen nt
    s_mov_b32 s99, 1048576
    buffer_load_dwordx4 v[168:171], v18, s[56:59], s99 offen nt
G_50:
    s_nop 6
HSEG3:
    ds_write_b128 v25, v[144:147] offset:2048
    ds_write_b128 v25, v[148:151] offset:4096
    s_waitcnt lgkmcnt(0)

    s_cbranch_execz G_51
    s_barrier
    s_cmp_ge_u32 s3, 2
    s_cbranch_scc1 Hnogu

G_51:
    ds_read2st64_b32 v[52:53], v48 offset0:8 offset1:9
    ds_read2st64_b32 v[54:55], v48 offset0:10 offset1:11
    ds_read2st64_b32 v[56:57], v48 offset0:12 offset1:13
    ds_read2st64_b32 v[58:59], v48 offset0:14 offset1:15
    s_waitcnt lgkmcnt(0)
    v_add_f32 v52, v52, v53
    v_add_f32 v54, v54, v55
    v_add_f32 v56, v56, v57
    v_add_f32 v58, v58, v59
    v_add_f32 v52, v52, v54
    v_add_f32 v56, v56, v58
    v_add_f32 v52, v52, v56
    v_add_u32 v52, v52, v11
    v_bfi_b32 v52, s70, v10, v52

    s_cbranch_execz HSEG3b
    buffer_store_dword v52, v34, s[40:43], s60 offen sc1
Hnogu:

    s_cbranch_execz G_52
    s_waitcnt vmcnt(4)
G_52:
    s_cbranch_execz G_53
    s_waitcnt vmcnt(3)
    s_mov_b32 s99, 1310720
    buffer_load_dwordx4 v[172:175], v18, s[56:59], s99 offen nt
G_53:
    s_cbranch_execz G_54
    s_waitcnt vmcnt(3)
    s_mov_b32 s99, 1572864
    buffer_load_dwordx4 v[176:179], v18, s[56:59], s99 offen nt
G_54:
    s_cbranch_execz G_55
    s_waitcnt vmcnt(3)
    s_mov_b32 s99, 1835008
    buffer_load_dwordx4 v[180:183], v18, s[56:59], s99 offen nt
G_55:
    s_cbranch_execz G_56
    s_waitcnt vmcnt(3)
    buffer_load_dwordx4 a[64:67], v29, s[12:15], 0 offen offset:0 nt
G_56:
    s_cbranch_execz G_57
    s_waitcnt vmcnt(3)
    buffer_load_dwordx4 a[68:71], v29, s[12:15], 0 offen offset:2048 nt
    s_movk_i32 s99, 4096
    buffer_load_dwordx4 a[72:75], v29, s[12:15], s99 offen offset:0 nt
    s_movk_i32 s99, 4096
    buffer_load_dwordx4 a[76:79], v29, s[12:15], s99 offen offset:2048 nt
G_57:
    s_cbranch_execz G_58
    s_waitcnt vmcnt(5)
    s_movk_i32 s99, 8192
    buffer_load_dwordx4 a[80:83], v29, s[12:15], s99 offen offset:0 nt
G_58:
    s_cbranch_execz G_59
    s_waitcnt vmcnt(5)
    buffer_load_dword v232, v30, s[40:43], s61 offen offset:0 sc1
    buffer_load_dword v233, v30, s[40:43], s61 offen offset:512 sc1
    buffer_load_dword v234, v30, s[40:43], s61 offen offset:1024 sc1
    buffer_load_dword v235, v30, s[40:43], s61 offen offset:1536 sc1
G_59:
    s_cbranch_execz G_60
    s_waitcnt vmcnt(8)
    s_movk_i32 s99, 8192
    buffer_load_dwordx4 a[84:87], v29, s[12:15], s99 offen offset:2048 nt
G_60:
    s_cbranch_execz G_61
    s_waitcnt vmcnt(8)
    s_movk_i32 s99, 12288
    buffer_load_dwordx4 a[88:91], v29, s[12:15], s99 offen offset:0 nt
G_61:
    s_cbranch_execz G_62
    s_waitcnt vmcnt(8)
    s_movk_i32 s99, 12288
    buffer_load_dwordx4 a[92:95], v29, s[12:15], s99 offen offset:2048 nt
G_62:
    s_cbranch_execz G_63
    s_waitcnt vmcnt(8)
G_63:
    s_cbranch_execz G_64
    s_waitcnt vmcnt(7)
G_64:
HSEG3b:
    s_cbranch_execz G_65
    s_waitcnt vmcnt(3)
G_65:
    v_msad_u8 v60, v232, v10, 0
    v_msad_u8 v61, v233, v10, 0
    v_msad_u8 v60, v234, v10, v60
    v_msad_u8 v61, v235, v10, v61
    v_or_b32 v60, v60, v61
    v_cmp_ne_u32 vcc, 0, v60

    s_nop 1
    s_cbranch_vccz Hrh_ok
    s_mov_b32 s71, 1048576
Hrh:

    buffer_load_dword v232, v30, s[40:43], s61 offen offset:0 sc1
    buffer_load_dword v233, v30, s[40:43], s61 offen offset:512 sc1
    buffer_load_dword v234, v30, s[40:43], s61 offen offset:1024 sc1
    buffer_load_dword v235, v30, s[40:43], s61 offen offset:1536 sc1
    s_waitcnt vmcnt(0)
    v_msad_u8 v60, v232, v10, 0
    v_msad_u8 v61, v233, v10, 0
    v_msad_u8 v60, v234, v10, v60
    v_msad_u8 v61, v235, v10, v61
    v_or_b32 v60, v60, v61
    v_cmp_ne_u32 vcc, 0, v60

    s_sub_u32 s71, s71, 1
    s_cmp_eq_u32 s71, 0
    s_cbranch_scc1 Hrh_ok
    s_cbranch_vccnz Hrh
Hrh_ok:

    s_cbranch_execz G_66
    buffer_load_dword v216, v33, s[40:43], s69 offen sc1
G_66:
    v_add_f32 v232, v232, v233
    v_add_f32 v234, v234, v235
    s_nop 0
    v_add_f32_dpp v232, v232, v232 row_ror:8 row_mask:0xf bank_mask:0xf
    v_add_f32_dpp v234, v234, v234 row_ror:8 row_mask:0xf bank_mask:0xf

    v_cvt_pk_bf16_f32 v232, v232, v232
    v_and_b32 v232, 0xffff0000, v232

    v_mul_f32 v56, 3216550459, v232
    v_exp_f32 v56, v56

    v_cvt_pk_bf16_f32 v234, v234, v234
    v_and_b32 v234, 0xffff0000, v234

    v_add_f32 v56, 1.0, v56
    v_rcp_f32 v56, v56
    s_nop 0
    v_mul_f32 v232, v232, v56

    v_cvt_pk_bf16_f32 v232, v232, v232
    v_and_b32 v232, 0xffff0000, v232

    v_mul_f32 v232, v232, v234
    v_cvt_pk_bf16_f32 v232, v232, v232
    s_nop 1

    v_and_b32_dpp v76, v232, v2 row_newbcast:0 row_mask:0xf bank_mask:0xf
    v_and_b32_dpp v77, v232, v3 row_newbcast:0 row_mask:0xf bank_mask:0xf
    v_and_b32_dpp v78, v232, v4 row_newbcast:0 row_mask:0xf bank_mask:0xf
    v_and_b32_dpp v79, v232, v5 row_newbcast:0 row_mask:0xf bank_mask:0xf
    v_and_b32_dpp v80, v232, v2 row_newbcast:1 row_mask:0xf bank_mask:0xf
    v_and_b32_dpp v81, v232, v3 row_newbcast:1 row_mask:0xf bank_mask:0xf
    v_and_b32_dpp v82, v232, v4 row_newbcast:1 row_mask:0xf bank_mask:0xf
    v_and_b32_dpp v83, v232, v5 row_newbcast:1 row_mask:0xf bank_mask:0xf
    v_mfma_f32_16x16x32_bf16 v[144:147], v[76:79], a[64:67], 0
    v_and_b32_dpp v84, v232, v2 row_newbcast:2 row_mask:0xf bank_mask:0xf
    v_and_b32_dpp v85, v232, v3 row_newbcast:2 row_mask:0xf bank_mask:0xf
    v_and_b32_dpp v86, v232, v4 row_newbcast:2 row_mask:0xf bank_mask:0xf
    v_and_b32_dpp v87, v232, v5 row_newbcast:2 row_mask:0xf bank_mask:0xf
    v_mfma_f32_16x16x32_bf16 v[144:147], v[80:83], a[68:71], v[144:147]
    v_and_b32_dpp v88, v232, v2 row_newbcast:3 row_mask:0xf bank_mask:0xf
    v_and_b32_dpp v89, v232, v3 row_newbcast:3 row_mask:0xf bank_mask:0xf
    v_and_b32_dpp v90, v232, v4 row_newbcast:3 row_mask:0xf bank_mask:0xf
    v_and_b32_dpp v91, v232, v5 row_newbcast:3 row_mask:0xf bank_mask:0xf
    v_mfma_f32_16x16x32_bf16 v[144:147], v[84:87], a[72:75], v[144:147]
    v_and_b32_dpp v92, v232, v2 row_newbcast:4 row_mask:0xf bank_mask:0xf
    v_and_b32_dpp v93, v232, v3 row_newbcast:4 row_mask:0xf bank_mask:0xf
    v_and_b32_dpp v94, v232, v4 row_newbcast:4 row_mask:0xf bank_mask:0xf
    v_and_b32_dpp v95, v232, v5 row_newbcast:4 row_mask:0xf bank_mask:0xf
    v_mfma_f32_16x16x32_bf16 v[144:147], v[88:91], a[76:79], v[144:147]
    v_and_b32_dpp v96, v232, v2 row_newbcast:5 row_mask:0xf bank_mask:0xf
    v_and_b32_dpp v97, v232, v3 row_newbcast:5 row_mask:0xf bank_mask:0xf
    v_and_b32_dpp v98, v232, v4 row_newbcast:5 row_mask:0xf bank_mask:0xf
    v_and_b32_dpp v99, v232, v5 row_newbcast:5 row_mask:0xf bank_mask:0xf
    v_mfma_f32_16x16x32_bf16 v[144:147], v[92:95], a[80:83], v[144:147]
    v_and_b32_dpp v100, v232, v2 row_newbcast:6 row_mask:0xf bank_mask:0xf
    v_and_b32_dpp v101, v232, v3 row_newbcast:6 row_mask:0xf bank_mask:0xf
    v_and_b32_dpp v102, v232, v4 row_newbcast:6 row_mask:0xf bank_mask:0xf
    v_and_b32_dpp v103, v232, v5 row_newbcast:6 row_mask:0xf bank_mask:0xf
    v_and_b32_dpp v104, v232, v2 row_newbcast:7 row_mask:0xf bank_mask:0xf
    v_and_b32_dpp v105, v232, v3 row_newbcast:7 row_mask:0xf bank_mask:0xf
    v_and_b32_dpp v106, v232, v4 row_newbcast:7 row_mask:0xf bank_mask:0xf
    v_and_b32_dpp v107, v232, v5 row_newbcast:7 row_mask:0xf bank_mask:0xf
    s_nop 1
    s_cbranch_execz HW_ret
    s_cbranch_execz G_67
    s_waitcnt vmcnt(3)
G_67:
    v_mfma_f32_16x16x32_bf16 v[144:147], v[96:99], a[84:87], v[144:147]
    s_cbranch_execz G_68
    s_waitcnt vmcnt(2)
G_68:
    v_mfma_f32_16x16x32_bf16 v[144:147], v[100:103], a[88:91], v[144:147]
    s_cbranch_execz G_69
    s_waitcnt vmcnt(1)
G_69:
    v_mfma_f32_16x16x32_bf16 v[144:147], v[104:107], a[92:95], v[144:147]
    s_nop 7
    ds_write_b128 v12, v[144:147] offset:16896

HSEG2:
    s_cbranch_execz G_71
    s_waitcnt vmcnt(0)
G_71:
    v_msad_u8 v55, v216, s46, 0
    v_cmp_ne_u32 vcc, 0, v55

    s_nop 1
    s_cbranch_vccz Hrf_ok
    s_mov_b32 s71, 1048576
Hrf:

    buffer_load_dword v216, v33, s[40:43], s69 offen sc1
    s_waitcnt vmcnt(0)
    v_msad_u8 v55, v216, s46, 0
    v_cmp_ne_u32 vcc, 0, v55

    s_sub_u32 s71, s71, 1
    s_cmp_eq_u32 s71, 0
    s_cbranch_scc1 Hrf_ok
    s_cbranch_vccnz Hrf
Hrf_ok:

    v_perm_b32 v218, v216, v216, s47
    s_nop 1
Hf_go:

    v_and_b32_dpp v184, v218, v2 row_newbcast:0 row_mask:0xf bank_mask:0xf
    v_and_b32_dpp v185, v218, v3 row_newbcast:0 row_mask:0xf bank_mask:0xf
    v_and_b32_dpp v186, v218, v4 row_newbcast:0 row_mask:0xf bank_mask:0xf
    v_and_b32_dpp v187, v218, v5 row_newbcast:0 row_mask:0xf bank_mask:0xf
    v_and_b32_dpp v188, v218, v2 row_newbcast:1 row_mask:0xf bank_mask:0xf
    v_and_b32_dpp v189, v218, v3 row_newbcast:1 row_mask:0xf bank_mask:0xf
    v_and_b32_dpp v190, v218, v4 row_newbcast:1 row_mask:0xf bank_mask:0xf
    v_and_b32_dpp v191, v218, v5 row_newbcast:1 row_mask:0xf bank_mask:0xf
    v_mfma_f32_16x16x32_bf16 v[128:131], v[184:187], v[152:155], 0
    v_and_b32_dpp v192, v218, v2 row_newbcast:2 row_mask:0xf bank_mask:0xf
    v_and_b32_dpp v193, v218, v3 row_newbcast:2 row_mask:0xf bank_mask:0xf
    v_and_b32_dpp v194, v218, v4 row_newbcast:2 row_mask:0xf bank_mask:0xf
    v_and_b32_dpp v195, v218, v5 row_newbcast:2 row_mask:0xf bank_mask:0xf
    v_mfma_f32_16x16x32_bf16 v[128:131], v[188:191], v[156:159], v[128:131]
    v_and_b32_dpp v196, v218, v2 row_newbcast:3 row_mask:0xf bank_mask:0xf
    v_and_b32_dpp v197, v218, v3 row_newbcast:3 row_mask:0xf bank_mask:0xf
    v_and_b32_dpp v198, v218, v4 row_newbcast:3 row_mask:0xf bank_mask:0xf
    v_and_b32_dpp v199, v218, v5 row_newbcast:3 row_mask:0xf bank_mask:0xf
    v_mfma_f32_16x16x32_bf16 v[128:131], v[192:195], v[160:163], v[128:131]
    v_and_b32_dpp v200, v218, v2 row_newbcast:4 row_mask:0xf bank_mask:0xf
    v_and_b32_dpp v201, v218, v3 row_newbcast:4 row_mask:0xf bank_mask:0xf
    v_and_b32_dpp v202, v218, v4 row_newbcast:4 row_mask:0xf bank_mask:0xf
    v_and_b32_dpp v203, v218, v5 row_newbcast:4 row_mask:0xf bank_mask:0xf
    v_mfma_f32_16x16x32_bf16 v[128:131], v[196:199], v[164:167], v[128:131]
    v_and_b32_dpp v204, v218, v2 row_newbcast:5 row_mask:0xf bank_mask:0xf
    v_and_b32_dpp v205, v218, v3 row_newbcast:5 row_mask:0xf bank_mask:0xf
    v_and_b32_dpp v206, v218, v4 row_newbcast:5 row_mask:0xf bank_mask:0xf
    v_and_b32_dpp v207, v218, v5 row_newbcast:5 row_mask:0xf bank_mask:0xf
    v_mfma_f32_16x16x32_bf16 v[128:131], v[200:203], v[168:171], v[128:131]
    v_and_b32_dpp v208, v218, v2 row_newbcast:6 row_mask:0xf bank_mask:0xf
    v_and_b32_dpp v209, v218, v3 row_newbcast:6 row_mask:0xf bank_mask:0xf
    v_and_b32_dpp v210, v218, v4 row_newbcast:6 row_mask:0xf bank_mask:0xf
    v_and_b32_dpp v211, v218, v5 row_newbcast:6 row_mask:0xf bank_mask:0xf
    v_mfma_f32_16x16x32_bf16 v[128:131], v[204:207], v[172:175], v[128:131]
    v_and_b32_dpp v212, v218, v2 row_newbcast:7 row_mask:0xf bank_mask:0xf
    v_and_b32_dpp v213, v218, v3 row_newbcast:7 row_mask:0xf bank_mask:0xf
    v_and_b32_dpp v214, v218, v4 row_newbcast:7 row_mask:0xf bank_mask:0xf
    v_and_b32_dpp v215, v218, v5 row_newbcast:7 row_mask:0xf bank_mask:0xf
    v_mfma_f32_16x16x32_bf16 v[128:131], v[208:211], v[176:179], v[128:131]
    s_nop 1
    v_mfma_f32_16x16x32_bf16 v[128:131], v[212:215], v[180:183], v[128:131]
    s_add_u32 s99, s62, 262144
    s_nop 6
    ds_write_b128 v12, v[128:131] offset:14848

    s_waitcnt lgkmcnt(0)
    s_cbranch_execz G_73
    s_barrier
G_73:
    ds_read2st64_b32 v[52:53], v35 offset0:58 offset1:60
    ds_read2st64_b32 v[54:55], v35 offset0:62 offset1:64
    s_cmp_ge_u32 s3, 2
    s_waitcnt lgkmcnt(0)
    v_add_f32 v52, v52, v53
    v_add_f32 v54, v54, v55
    v_add_f32 v52, v52, v54
    v_add_u32 v52, v52, v11
    v_bfi_b32 v52, s70, v10, v52

    s_cbranch_execz HW_ret
    buffer_store_dword v52, v13, s[40:43], s62 offen
    buffer_store_dword v52, v13, s[40:43], s99 offen sc1

    s_endpgm
L_light:
    buffer_load_dwordx4 v36, s[52:55], s63 offen offset:2048 nt lds
    buffer_load_dwordx4 v36, s[52:55], s63 offen offset:3072 nt lds
    s_mov_b64 exec, 0
    s_cmp_eq_u32 s3, 0
    s_cbranch_scc1 LtSEG0
    s_cmp_eq_u32 s3, 1
    s_cbranch_scc1 LtSEG1
    s_cmp_eq_u32 s3, 2
    s_cbranch_scc1 LtSEG2
    s_branch LtSEG3
LtW_ret:
    s_mov_b64 exec, -1

    s_cbranch_execz G_74
    s_waitcnt vmcnt(7)
G_74:
    s_cbranch_execz G_75
    s_waitcnt vmcnt(6)
G_75:
    s_cbranch_execz G_76
    s_waitcnt vmcnt(5)
G_76:
    s_cbranch_execz G_77
    s_waitcnt vmcnt(4)
G_77:
    s_cbranch_execz G_78
    s_waitcnt vmcnt(3)
G_78:
    s_cbranch_execz G_79
    s_waitcnt vmcnt(2)
G_79:
    s_cbranch_execz G_80
    s_waitcnt vmcnt(1)
    buffer_load_dwordx4 v[216:219], v6, s[40:43], s20 offen sc1
    s_add_u32 s99, s20, 4096
    buffer_load_dwordx4 v[220:223], v6, s[40:43], s99 offen sc1
    s_add_u32 s99, s20, 8192
    buffer_load_dwordx4 v[224:227], v6, s[40:43], s99 offen sc1
    s_add_u32 s99, s20, 12288
    buffer_load_dwordx4 v[228:231], v6, s[40:43], s99 offen sc1
G_80:
    s_cbranch_execz G_81
    s_waitcnt vmcnt(4)
G_81:
    s_barrier
    ds_read_b64_tr_b16 v[200:201], v24 offset:23040
    ds_read_b64_tr_b16 v[202:203], v24 offset:24064
    ds_read_b64_tr_b16 v[204:205], v24 offset:23072
    ds_read_b64_tr_b16 v[206:207], v24 offset:24096
    ds_read_b64_tr_b16 v[208:209], v24 offset:31232
    ds_read_b64_tr_b16 v[210:211], v24 offset:32256
    ds_read_b64_tr_b16 v[212:213], v24 offset:31264
    ds_read_b64_tr_b16 v[214:215], v24 offset:32288
LtSEG0:
    v_mov_b32 v52, 0
    v_mov_b32 v53, 0

    s_cbranch_execz G_82
    s_waitcnt vmcnt(3)
G_82:
    v_msad_u8 v52, v216, s28, v52
    v_msad_u8 v53, v217, s29, v53
    v_msad_u8 v52, v218, s30, v52
    v_msad_u8 v53, v219, s31, v53
    s_cbranch_execz G_83
    s_waitcnt vmcnt(2)
G_83:
    v_msad_u8 v52, v220, s28, v52
    v_msad_u8 v53, v221, s29, v53
    v_msad_u8 v52, v222, s30, v52
    v_msad_u8 v53, v223, s31, v53
    s_cbranch_execz G_84
    s_waitcnt vmcnt(1)
G_84:
    v_msad_u8 v52, v224, s28, v52
    v_msad_u8 v53, v225, s29, v53
    v_msad_u8 v52, v226, s30, v52
    v_msad_u8 v53, v227, s31, v53
    s_cbranch_execz G_85
    s_waitcnt vmcnt(0)
G_85:
    v_msad_u8 v52, v228, s28, v52
    v_msad_u8 v53, v229, s29, v53
    v_msad_u8 v52, v230, s30, v52
    v_msad_u8 v53, v231, s31, v53
    v_or_b32 v52, v52, v53
    v_cmp_ne_u32 vcc, 0, v52

    s_nop 1
    s_cbranch_vccz Ltrq_ok
    s_mov_b32 s71, 1048576
Ltrq:

    buffer_load_dwordx4 v[216:219], v6, s[40:43], s20 offen sc1
    s_add_u32 s99, s20, 4096
    buffer_load_dwordx4 v[220:223], v6, s[40:43], s99 offen sc1
    s_add_u32 s99, s20, 8192
    buffer_load_dwordx4 v[224:227], v6, s[40:43], s99 offen sc1
    s_add_u32 s99, s20, 12288
    buffer_load_dwordx4 v[228:231], v6, s[40:43], s99 offen sc1
    s_waitcnt vmcnt(0)
    v_mov_b32 v52, 0
    v_mov_b32 v53, 0

    v_msad_u8 v52, v216, s28, v52
    v_msad_u8 v53, v217, s29, v53
    v_msad_u8 v52, v218, s30, v52
    v_msad_u8 v53, v219, s31, v53
    v_msad_u8 v52, v220, s28, v52
    v_msad_u8 v53, v221, s29, v53
    v_msad_u8 v52, v222, s30, v52
    v_msad_u8 v53, v223, s31, v53
    v_msad_u8 v52, v224, s28, v52
    v_msad_u8 v53, v225, s29, v53
    v_msad_u8 v52, v226, s30, v52
    v_msad_u8 v53, v227, s31, v53
    v_msad_u8 v52, v228, s28, v52
    v_msad_u8 v53, v229, s29, v53
    v_msad_u8 v52, v230, s30, v52
    v_msad_u8 v53, v231, s31, v53
    v_or_b32 v52, v52, v53
    v_cmp_ne_u32 vcc, 0, v52

    s_sub_u32 s71, s71, 1
    s_cmp_eq_u32 s71, 0
    s_cbranch_scc1 Ltrq_ok
    s_cbranch_vccnz Ltrq
Ltrq_ok:

    v_pk_add_f32 v[56:57], v[216:217], v[220:221]
    v_pk_add_f32 v[58:59], v[218:219], v[222:223]
    v_pk_add_f32 v[60:61], v[224:225], v[228:229]
    v_pk_add_f32 v[62:63], v[226:227], v[230:231]
    v_pk_add_f32 v[56:57], v[56:57], v[60:61]
    v_pk_add_f32 v[58:59], v[58:59], v[62:63]
    v_cvt_pk_bf16_f32 v56, v56, v57
    v_cvt_pk_bf16_f32 v57, v58, v59
    ds_write_b64 v20, v[56:57] offset:11264

    s_waitcnt lgkmcnt(0)
    s_cbranch_execz G_88
    s_barrier
G_88:
    ds_read_b128 v[108:111], v21 offset:11264
    ds_read_b128 v[112:115], v21 offset:11328
    ds_read_b128 v[116:119], v21 offset:11392
    ds_read_b128 v[120:123], v21 offset:11456

    s_waitcnt lgkmcnt(3)
    v_mfma_f32_16x16x32_bf16 v[124:127], v[184:187], v[108:111], 0
    s_waitcnt lgkmcnt(2)
    v_mfma_f32_16x16x32_bf16 v[124:127], v[188:191], v[112:115], v[124:127]
    s_waitcnt lgkmcnt(1)
    v_mfma_f32_16x16x32_bf16 v[124:127], v[192:195], v[116:119], v[124:127]
    s_waitcnt lgkmcnt(0)
    v_mfma_f32_16x16x32_bf16 v[124:127], v[196:199], v[120:123], v[124:127]
    s_nop 7
    v_cvt_pk_bf16_f32 v52, v124, v125
    v_cvt_pk_bf16_f32 v53, v126, v127
    v_lshlrev_b32 v56, 16, v52
    v_and_b32 v57, 0xffff0000, v52
    v_lshlrev_b32 v58, 16, v53
    v_and_b32 v59, 0xffff0000, v53
    v_mul_f32 v56, s24, v56
    v_mul_f32 v57, s24, v57
    v_mul_f32 v58, s24, v58
    v_mul_f32 v59, s24, v59
    v_cvt_pk_bf16_f32 v52, v56, v57
    v_cvt_pk_bf16_f32 v53, v58, v59
    ds_write_b64 v22, v[52:53] offset:13440
    s_waitcnt lgkmcnt(0)

    s_cbranch_execz LtW_ret
    s_barrier
LtSEG1:
    ds_read_b128 v[52:55], v23 offset:13440

    s_waitcnt lgkmcnt(0)
    v_lshlrev_b32 v56, 16, v52
    v_and_b32 v57, 0xffff0000, v52

    v_lshlrev_b32 v58, 16, v53
    v_and_b32 v59, 0xffff0000, v53

    v_lshlrev_b32 v60, 16, v54
    v_and_b32 v61, 0xffff0000, v54

    v_lshlrev_b32 v62, 16, v55
    v_and_b32 v63, 0xffff0000, v55

    v_max3_f32 v64, v56, v57, v58
    v_max3_f32 v65, v59, v60, v61
    v_max3_f32 v64, v62, v63, v64
    v_max_f32 v64, v64, v65

    s_nop 1
    v_max_f32_dpp v64, v64, v64 row_ror:8 row_mask:0xf bank_mask:0xf

    v_mov_b32 v65, v64
    s_nop 1
    v_permlane16_swap_b32 v65, v64
    v_max_f32 v64, v64, v65

    v_mov_b32 v65, v64
    s_nop 1
    v_permlane32_swap_b32 v65, v64
    v_max_f32 v64, v64, v65

    v_mul_f32 v64, s25, v64
    v_fma_f32 v56, v56, s25, -v64
    v_fma_f32 v57, v57, s25, -v64
    v_fma_f32 v58, v58, s25, -v64
    v_fma_f32 v59, v59, s25, -v64
    v_fma_f32 v60, v60, s25, -v64
    v_fma_f32 v61, v61, s25, -v64
    v_fma_f32 v62, v62, s25, -v64
    v_fma_f32 v63, v63, s25, -v64
    v_exp_f32 v56, v56
    v_exp_f32 v57, v57
    v_exp_f32 v58, v58
    v_exp_f32 v59, v59
    v_exp_f32 v60, v60
    v_exp_f32 v61, v61
    v_exp_f32 v62, v62
    v_exp_f32 v63, v63
    v_cvt_pk_bf16_f32 v72, v56, v57
    v_cvt_pk_bf16_f32 v73, v58, v59
    v_cvt_pk_bf16_f32 v74, v60, v61
    v_cvt_pk_bf16_f32 v75, v62, v63
    v_pk_add_f32 v[52:53], v[56:57], v[58:59]
    v_pk_add_f32 v[54:55], v[60:61], v[62:63]

    v_mfma_f32_16x16x32_bf16 v[128:131], v[200:203], v[72:75], 0
    v_mfma_f32_16x16x32_bf16 v[136:139], v[208:211], v[72:75], 0
    v_mfma_f32_16x16x32_bf16 v[132:135], v[204:207], v[72:75], 0
    v_mfma_f32_16x16x32_bf16 v[140:143], v[212:215], v[72:75], 0
    v_pk_add_f32 v[52:53], v[52:53], v[54:55]
    v_add_f32 v66, v52, v53

    s_nop 1
    v_add_f32_dpp v66, v66, v66 row_ror:8 row_mask:0xf bank_mask:0xf

    v_mov_b32 v65, v66
    s_nop 1
    v_permlane16_swap_b32 v65, v66
    v_add_f32 v66, v66, v65

    v_mov_b32 v65, v66
    s_nop 1
    v_permlane32_swap_b32 v65, v66
    v_add_f32 v66, v66, v65

    v_log_f32 v67, v66
    v_rcp_f32 v68, v66

    v_add_f32_dpp v124, v136, v128 row_ror:8 row_mask:0xf bank_mask:0x3
    v_add_f32_dpp v125, v137, v129 row_ror:8 row_mask:0xf bank_mask:0x3
    v_add_f32_dpp v126, v138, v130 row_ror:8 row_mask:0xf bank_mask:0x3
    v_add_f32_dpp v127, v139, v131 row_ror:8 row_mask:0xf bank_mask:0x3
    v_add_f32 v67, v67, v64
    v_add_f32_dpp v124, v132, v140 row_ror:8 row_mask:0xf bank_mask:0xc
    v_add_f32_dpp v125, v133, v141 row_ror:8 row_mask:0xf bank_mask:0xc
    v_add_f32_dpp v126, v134, v142 row_ror:8 row_mask:0xf bank_mask:0xc
    v_add_f32_dpp v127, v135, v143 row_ror:8 row_mask:0xf bank_mask:0xc
    v_add_u32 v67, 0x80, v67
    v_bfi_b32 v67, s70, v10, v67

    v_mul_f32 v124, v124, v68
    v_mul_f32 v125, v125, v68
    v_mul_f32 v126, v126, v68
    v_mul_f32 v127, v127, v68
    v_perm_b32 v124, v124, v67, s26
    v_perm_b32 v125, v125, v67, s27
    v_perm_b32 v126, v126, v67, s66
    v_perm_b32 v127, v127, v67, s67
    s_cbranch_execz LtW_ret
    buffer_store_dwordx4 v[124:127], v6, s[40:43], s23 offen sc1
    buffer_load_dwordx4 v[152:155], v18, s[56:59], 0 offen nt
    s_mov_b32 s99, 262144
    buffer_load_dwordx4 v[156:159], v18, s[56:59], s99 offen nt
    s_mov_b32 s99, 524288
    buffer_load_dwordx4 v[160:163], v18, s[56:59], s99 offen nt
    s_mov_b32 s99, 786432
    buffer_load_dwordx4 v[164:167], v18, s[56:59], s99 offen nt
    s_mov_b32 s99, 1048576
    buffer_load_dwordx4 v[168:171], v18, s[56:59], s99 offen nt
    s_mov_b32 s99, 1310720
    buffer_load_dwordx4 v[172:175], v18, s[56:59], s99 offen nt
    s_mov_b32 s99, 1572864
    buffer_load_dwordx4 v[176:179], v18, s[56:59], s99 offen nt
    s_mov_b32 s99, 1835008
    buffer_load_dwordx4 v[180:183], v18, s[56:59], s99 offen nt
    s_cbranch_execz G_92
    s_waitcnt vmcnt(7)
G_92:
    s_cbranch_execz G_93
    s_waitcnt vmcnt(6)
G_93:
    s_cbranch_execz G_94
    s_waitcnt vmcnt(5)
G_94:
    s_cbranch_execz G_95
    s_waitcnt vmcnt(4)
G_95:
    s_cbranch_execz G_96
    s_waitcnt vmcnt(3)
G_96:
    s_cbranch_execz G_97
    s_waitcnt vmcnt(2)
G_97:
    s_cbranch_execz G_98
    s_waitcnt vmcnt(1)
G_98:
    s_cbranch_execz G_99
    s_waitcnt vmcnt(0)
G_99:
    v_lshlrev_b32 v19, 12, v7
    v_lshl_add_u32 v19, v8, 4, v19
    s_lshr_b32 s64, s34, 3
    s_lshl_b32 s65, s33, 2
    s_add_u32 s65, s65, s64
    s_lshl_b32 s64, s65, 2
    s_add_u32 s64, s64, s3
    s_lshl_b32 s60, s64, 7
    s_add_u32 s60, s60, 131072
    s_and_b32 s64, s64, 31
    s_lshl_b32 s64, s64, 7
    s_add_u32 s22, s22, s64
    s_mov_b32 s71, 1048576
    s_mov_b32 s52, 0x01010101
    s_mov_b32 s53, 0x01010101

    s_mov_b64 s[4:5], -1
    s_mov_b64 s[6:7], -1
    s_mov_b64 s[8:9], -1
    s_mov_b64 s[10:11], -1
    s_mov_b64 s[12:13], -1
    s_mov_b64 s[14:15], -1
    s_mov_b64 s[48:49], -1
    s_mov_b64 s[50:51], -1
    s_lshl_b32 s54, s65, 5
    s_lshl_b32 s96, s3, 3
    s_add_u32 s54, s54, s96
    v_and_b32 v45, 1, v1
    v_lshl_add_u32 v44, v45, 2, v32
    v_add_u32 v44, s54, v44
    v_lshlrev_b32 v44, 1, v44
    buffer_load_ushort v43, v44, s[36:39], 0 offen
    v_lshrrev_b32 v40, 1, v1
    v_and_b32 v41, 7, v40
    v_cmp_ne_u32 vcc, 3, v41
    v_lshlrev_b32 v40, 10, v40
    v_lshl_add_u32 v40, v45, 4, v40
    v_add_u32 v41, 512, v40
    v_cndmask_b32 v41, v40, v41, vcc
    v_cndmask_b32 v42, 0, 1.0, vcc
    v_and_b32 v45, 14, v1
    v_cmp_eq_u32 s[56:57], 0, v45
    s_lshl_b32 s55, s33, 15
    s_lshr_b32 s64, s34, 3
    s_lshl_b32 s64, s64, 7
    s_add_u32 s55, s55, s64
    s_lshl_b32 s96, s3, 5
    s_add_u32 s55, s55, s96
    s_add_u32 s54, s55, 2359296
    s_add_u32 s55, s55, 2097152

    s_waitcnt vmcnt(0)

C_poll:

    s_mov_b64 exec, s[4:5]
    s_cbranch_execz C_i0
    s_add_u32 s99, s22, 0
    buffer_load_dwordx4 v[76:79], v19, s[40:43], s99 offen sc1
C_i0:

    s_mov_b64 exec, s[6:7]
    s_cbranch_execz C_i1
    s_add_u32 s99, s22, 32768
    buffer_load_dwordx4 v[80:83], v19, s[40:43], s99 offen sc1
C_i1:

    s_mov_b64 exec, s[8:9]
    s_cbranch_execz C_i2
    s_add_u32 s99, s22, 65536
    buffer_load_dwordx4 v[84:87], v19, s[40:43], s99 offen sc1
C_i2:

    s_mov_b64 exec, s[10:11]
    s_cbranch_execz C_i3
    s_add_u32 s99, s22, 98304
    buffer_load_dwordx4 v[88:91], v19, s[40:43], s99 offen sc1
C_i3:

    s_mov_b64 exec, s[12:13]
    s_cbranch_execz C_i4
    s_add_u32 s99, s22, 131072
    buffer_load_dwordx4 v[92:95], v19, s[40:43], s99 offen sc1
C_i4:

    s_mov_b64 exec, s[14:15]
    s_cbranch_execz C_i5
    s_add_u32 s99, s22, 163840
    buffer_load_dwordx4 v[96:99], v19, s[40:43], s99 offen sc1
C_i5:

    s_mov_b64 exec, s[48:49]
    s_cbranch_execz C_i6
    s_add_u32 s99, s22, 196608
    buffer_load_dwordx4 v[100:103], v19, s[40:43], s99 offen sc1
C_i6:

    s_mov_b64 exec, s[50:51]
    s_cbranch_execz C_i7
    s_add_u32 s99, s22, 229376
    buffer_load_dwordx4 v[104:107], v19, s[40:43], s99 offen sc1
C_i7:

    s_mov_b64 exec, -1
    s_waitcnt vmcnt(0)
LtSEG2:
    v_msad_u8 v52, v76, v10, 0
    v_perm_b32 v108, v78, v77, s68
    v_lshl_or_b32 v108, v79, 24, v108

    v_msad_u8 v53, v80, v10, 0
    v_perm_b32 v109, v82, v81, s68
    v_lshl_or_b32 v109, v83, 24, v109

    v_msad_u8 v54, v84, v10, 0
    v_perm_b32 v110, v86, v85, s68
    v_lshl_or_b32 v110, v87, 24, v110

    v_msad_u8 v55, v88, v10, 0
    v_perm_b32 v111, v90, v89, s68
    v_lshl_or_b32 v111, v91, 24, v111

    v_msad_u8 v56, v92, v10, 0
    v_perm_b32 v112, v94, v93, s68
    v_lshl_or_b32 v112, v95, 24, v112

    v_msad_u8 v57, v96, v10, 0
    v_perm_b32 v113, v98, v97, s68
    v_lshl_or_b32 v113, v99, 24, v113

    v_msad_u8 v58, v100, v10, 0
    v_perm_b32 v114, v102, v101, s68
    v_lshl_or_b32 v114, v103, 24, v114

    v_msad_u8 v59, v104, v10, 0
    v_perm_b32 v115, v106, v105, s68
    v_lshl_or_b32 v115, v107, 24, v115

    v_or3_b32 v60, v52, v53, v54
    v_or3_b32 v61, v55, v56, v57
    v_or3_b32 v60, v58, v59, v60
    v_or_b32 v60, v60, v61
    v_cmp_ne_u32 vcc, 0, v60
    v_max3_f32 v62, v108, v109, v110
    v_max3_f32 v63, v111, v112, v113
    s_cbranch_vccz C_ok

    v_cmp_ne_u32 s[4:5], 0, v52
    v_cmp_ne_u32 s[6:7], 0, v53
    v_cmp_ne_u32 s[8:9], 0, v54
    v_cmp_ne_u32 s[10:11], 0, v55
    v_cmp_ne_u32 s[12:13], 0, v56
    v_cmp_ne_u32 s[14:15], 0, v57
    v_cmp_ne_u32 s[48:49], 0, v58
    v_cmp_ne_u32 s[50:51], 0, v59
    s_nop 1
    s_lshr_b64 s[96:97], s[4:5], 4
    s_or_b64 s[4:5], s[4:5], s[96:97]
    s_lshr_b64 s[96:97], s[4:5], 2
    s_or_b64 s[4:5], s[4:5], s[96:97]
    s_lshr_b64 s[96:97], s[4:5], 1
    s_or_b64 s[4:5], s[4:5], s[96:97]
    s_and_b64 s[4:5], s[4:5], s[52:53]
    s_mul_i32 s4, s4, 0xff
    s_mul_i32 s5, s5, 0xff

    s_lshr_b64 s[96:97], s[6:7], 4
    s_or_b64 s[6:7], s[6:7], s[96:97]
    s_lshr_b64 s[96:97], s[6:7], 2
    s_or_b64 s[6:7], s[6:7], s[96:97]
    s_lshr_b64 s[96:97], s[6:7], 1
    s_or_b64 s[6:7], s[6:7], s[96:97]
    s_and_b64 s[6:7], s[6:7], s[52:53]
    s_mul_i32 s6, s6, 0xff
    s_mul_i32 s7, s7, 0xff

    s_lshr_b64 s[96:97], s[8:9], 4
    s_or_b64 s[8:9], s[8:9], s[96:97]
    s_lshr_b64 s[96:97], s[8:9], 2
    s_or_b64 s[8:9], s[8:9], s[96:97]
    s_lshr_b64 s[96:97], s[8:9], 1
    s_or_b64 s[8:9], s[8:9], s[96:97]
    s_and_b64 s[8:9], s[8:9], s[52:53]
    s_mul_i32 s8, s8, 0xff
    s_mul_i32 s9, s9, 0xff

    s_lshr_b64 s[96:97], s[10:11], 4
    s_or_b64 s[10:11], s[10:11], s[96:97]
    s_lshr_b64 s[96:97], s[10:11], 2
    s_or_b64 s[10:11], s[10:11], s[96:97]
    s_lshr_b64 s[96:97], s[10:11], 1
    s_or_b64 s[10:11], s[10:11], s[96:97]
    s_and_b64 s[10:11], s[10:11], s[52:53]
    s_mul_i32 s10, s10, 0xff
    s_mul_i32 s11, s11, 0xff

    s_lshr_b64 s[96:97], s[12:13], 4
    s_or_b64 s[12:13], s[12:13], s[96:97]
    s_lshr_b64 s[96:97], s[12:13], 2
    s_or_b64 s[12:13], s[12:13], s[96:97]
    s_lshr_b64 s[96:97], s[12:13], 1
    s_or_b64 s[12:13], s[12:13], s[96:97]
    s_and_b64 s[12:13], s[12:13], s[52:53]
    s_mul_i32 s12, s12, 0xff
    s_mul_i32 s13, s13, 0xff

    s_lshr_b64 s[96:97], s[14:15], 4
    s_or_b64 s[14:15], s[14:15], s[96:97]
    s_lshr_b64 s[96:97], s[14:15], 2
    s_or_b64 s[14:15], s[14:15], s[96:97]
    s_lshr_b64 s[96:97], s[14:15], 1
    s_or_b64 s[14:15], s[14:15], s[96:97]
    s_and_b64 s[14:15], s[14:15], s[52:53]
    s_mul_i32 s14, s14, 0xff
    s_mul_i32 s15, s15, 0xff

    s_lshr_b64 s[96:97], s[48:49], 4
    s_or_b64 s[48:49], s[48:49], s[96:97]
    s_lshr_b64 s[96:97], s[48:49], 2
    s_or_b64 s[48:49], s[48:49], s[96:97]
    s_lshr_b64 s[96:97], s[48:49], 1
    s_or_b64 s[48:49], s[48:49], s[96:97]
    s_and_b64 s[48:49], s[48:49], s[52:53]
    s_mul_i32 s48, s48, 0xff
    s_mul_i32 s49, s49, 0xff

    s_lshr_b64 s[96:97], s[50:51], 4
    s_or_b64 s[50:51], s[50:51], s[96:97]
    s_lshr_b64 s[96:97], s[50:51], 2
    s_or_b64 s[50:51], s[50:51], s[96:97]
    s_lshr_b64 s[96:97], s[50:51], 1
    s_or_b64 s[50:51], s[50:51], s[96:97]
    s_and_b64 s[50:51], s[50:51], s[52:53]
    s_mul_i32 s50, s50, 0xff
    s_mul_i32 s51, s51, 0xff

    s_sub_u32 s71, s71, 1
    s_cmp_lg_u32 s71, 0
    s_cbranch_scc1 C_poll
C_ok:

    v_max3_f32 v62, v114, v115, v62
    v_max_f32 v62, v62, v63

    s_nop 1
    v_max_f32_dpp v62, v62, v62 row_ror:8 row_mask:0xf bank_mask:0xf

    v_mov_b32 v63, v62
    s_nop 1
    v_permlane16_swap_b32 v63, v62
    v_max_f32 v62, v62, v63

    v_mov_b32 v63, v62
    s_nop 1
    v_permlane32_swap_b32 v63, v62
    v_max_f32 v62, v62, v63

    v_sub_f32 v108, v108, v62
    v_sub_f32 v109, v109, v62
    v_sub_f32 v110, v110, v62
    v_sub_f32 v111, v111, v62
    v_sub_f32 v112, v112, v62
    v_sub_f32 v113, v113, v62
    v_sub_f32 v114, v114, v62
    v_sub_f32 v115, v115, v62
    v_exp_f32 v108, v108
    v_exp_f32 v109, v109
    v_exp_f32 v110, v110
    v_exp_f32 v111, v111
    v_exp_f32 v112, v112
    v_exp_f32 v113, v113
    v_exp_f32 v114, v114
    v_exp_f32 v115, v115
    v_mul_f32 v76, v76, v108
    v_mul_f32 v77, v77, v108
    v_mul_f32 v78, v78, v108
    v_mul_f32 v79, v79, v108
    v_mul_f32 v80, v80, v109
    v_mul_f32 v81, v81, v109
    v_mul_f32 v82, v82, v109
    v_mul_f32 v83, v83, v109
    v_fmac_f32 v76, v84, v110
    v_fmac_f32 v77, v85, v110
    v_fmac_f32 v78, v86, v110
    v_fmac_f32 v79, v87, v110
    v_fmac_f32 v80, v88, v111
    v_fmac_f32 v81, v89, v111
    v_fmac_f32 v82, v90, v111
    v_fmac_f32 v83, v91, v111
    v_fmac_f32 v76, v92, v112
    v_fmac_f32 v77, v93, v112
    v_fmac_f32 v78, v94, v112
    v_fmac_f32 v79, v95, v112
    v_fmac_f32 v80, v96, v113
    v_fmac_f32 v81, v97, v113
    v_fmac_f32 v82, v98, v113
    v_fmac_f32 v83, v99, v113
    v_fmac_f32 v76, v100, v114
    v_fmac_f32 v77, v101, v114
    v_fmac_f32 v78, v102, v114
    v_fmac_f32 v79, v103, v114
    v_fmac_f32 v80, v104, v115
    v_fmac_f32 v81, v105, v115
    v_fmac_f32 v82, v106, v115
    v_fmac_f32 v83, v107, v115
    v_pk_add_f32 v[108:109], v[108:109], v[110:111]
    v_pk_add_f32 v[112:113], v[112:113], v[114:115]
    v_pk_add_f32 v[76:77], v[76:77], v[80:81]
    v_pk_add_f32 v[78:79], v[78:79], v[82:83]
    v_pk_add_f32 v[108:109], v[108:109], v[112:113]
    v_add_f32 v58, v108, v109

    v_mov_b32 v59, v58
    s_nop 0
    v_permlane32_swap_b32 v76, v78
    v_permlane32_swap_b32 v77, v79
    v_permlane32_swap_b32 v59, v58
    v_add_f32 v76, v76, v78
    v_add_f32 v77, v77, v79
    v_add_f32 v58, v58, v59
    s_nop 0
    v_mov_b32 v59, v58
    v_permlane16_swap_b32 v76, v77
    s_nop 0
    v_permlane16_swap_b32 v59, v58
    v_add_f32 v76, v76, v77
    v_add_f32 v58, v58, v59

    s_nop 0
    v_add_f32_dpp v76, v76, v76 row_ror:8 row_mask:0xf bank_mask:0xf
    v_add_f32_dpp v58, v58, v58 row_ror:8 row_mask:0xf bank_mask:0xf

    v_rcp_f32 v58, v58
    s_nop 0
    v_mul_f32 v76, v76, v58
    v_cvt_pk_bf16_f32 v76, v76, v76
    v_and_b32 v76, 0xffff0000, v76
    v_or_b32 v76, s46, v76

    s_cbranch_execz G_101
    buffer_store_dword v76, v33, s[40:43], s60 offen sc1
G_101:
    s_cbranch_execz G_102
    buffer_load_dword v216, v33, s[40:43], s69 offen sc1
G_102:
    s_cbranch_execz G_103
    s_waitcnt vmcnt(0)
G_103:
    v_msad_u8 v55, v216, s46, 0
    v_cmp_ne_u32 vcc, 0, v55

    s_nop 1
    s_cbranch_vccz Ltrf_ok
    s_mov_b32 s71, 1048576
Ltrf:

    buffer_load_dword v216, v33, s[40:43], s69 offen sc1
    s_waitcnt vmcnt(0)
    v_msad_u8 v55, v216, s46, 0
    v_cmp_ne_u32 vcc, 0, v55

    s_sub_u32 s71, s71, 1
    s_cmp_eq_u32 s71, 0
    s_cbranch_scc1 Ltrf_ok
    s_cbranch_vccnz Ltrf
Ltrf_ok:

    v_perm_b32 v218, v216, v216, s47
    s_nop 1
Ltf_go:

    v_and_b32_dpp v184, v218, v2 row_newbcast:0 row_mask:0xf bank_mask:0xf
    v_and_b32_dpp v185, v218, v3 row_newbcast:0 row_mask:0xf bank_mask:0xf
    v_and_b32_dpp v186, v218, v4 row_newbcast:0 row_mask:0xf bank_mask:0xf
    v_and_b32_dpp v187, v218, v5 row_newbcast:0 row_mask:0xf bank_mask:0xf
    v_and_b32_dpp v188, v218, v2 row_newbcast:1 row_mask:0xf bank_mask:0xf
    v_and_b32_dpp v189, v218, v3 row_newbcast:1 row_mask:0xf bank_mask:0xf
    v_and_b32_dpp v190, v218, v4 row_newbcast:1 row_mask:0xf bank_mask:0xf
    v_and_b32_dpp v191, v218, v5 row_newbcast:1 row_mask:0xf bank_mask:0xf
    v_mfma_f32_16x16x32_bf16 v[128:131], v[184:187], v[152:155], 0
    v_and_b32_dpp v192, v218, v2 row_newbcast:2 row_mask:0xf bank_mask:0xf
    v_and_b32_dpp v193, v218, v3 row_newbcast:2 row_mask:0xf bank_mask:0xf
    v_and_b32_dpp v194, v218, v4 row_newbcast:2 row_mask:0xf bank_mask:0xf
    v_and_b32_dpp v195, v218, v5 row_newbcast:2 row_mask:0xf bank_mask:0xf
    v_mfma_f32_16x16x32_bf16 v[128:131], v[188:191], v[156:159], v[128:131]
    v_and_b32_dpp v196, v218, v2 row_newbcast:3 row_mask:0xf bank_mask:0xf
    v_and_b32_dpp v197, v218, v3 row_newbcast:3 row_mask:0xf bank_mask:0xf
    v_and_b32_dpp v198, v218, v4 row_newbcast:3 row_mask:0xf bank_mask:0xf
    v_and_b32_dpp v199, v218, v5 row_newbcast:3 row_mask:0xf bank_mask:0xf
    v_mfma_f32_16x16x32_bf16 v[128:131], v[192:195], v[160:163], v[128:131]
    v_and_b32_dpp v200, v218, v2 row_newbcast:4 row_mask:0xf bank_mask:0xf
    v_and_b32_dpp v201, v218, v3 row_newbcast:4 row_mask:0xf bank_mask:0xf
    v_and_b32_dpp v202, v218, v4 row_newbcast:4 row_mask:0xf bank_mask:0xf
    v_and_b32_dpp v203, v218, v5 row_newbcast:4 row_mask:0xf bank_mask:0xf
    v_mfma_f32_16x16x32_bf16 v[128:131], v[196:199], v[164:167], v[128:131]
    v_and_b32_dpp v204, v218, v2 row_newbcast:5 row_mask:0xf bank_mask:0xf
    v_and_b32_dpp v205, v218, v3 row_newbcast:5 row_mask:0xf bank_mask:0xf
    v_and_b32_dpp v206, v218, v4 row_newbcast:5 row_mask:0xf bank_mask:0xf
    v_and_b32_dpp v207, v218, v5 row_newbcast:5 row_mask:0xf bank_mask:0xf
    v_mfma_f32_16x16x32_bf16 v[128:131], v[200:203], v[168:171], v[128:131]
    v_and_b32_dpp v208, v218, v2 row_newbcast:6 row_mask:0xf bank_mask:0xf
    v_and_b32_dpp v209, v218, v3 row_newbcast:6 row_mask:0xf bank_mask:0xf
    v_and_b32_dpp v210, v218, v4 row_newbcast:6 row_mask:0xf bank_mask:0xf
    v_and_b32_dpp v211, v218, v5 row_newbcast:6 row_mask:0xf bank_mask:0xf
    v_mfma_f32_16x16x32_bf16 v[128:131], v[204:207], v[172:175], v[128:131]
    v_and_b32_dpp v212, v218, v2 row_newbcast:7 row_mask:0xf bank_mask:0xf
    v_and_b32_dpp v213, v218, v3 row_newbcast:7 row_mask:0xf bank_mask:0xf
    v_and_b32_dpp v214, v218, v4 row_newbcast:7 row_mask:0xf bank_mask:0xf
    v_and_b32_dpp v215, v218, v5 row_newbcast:7 row_mask:0xf bank_mask:0xf
    v_mfma_f32_16x16x32_bf16 v[128:131], v[208:211], v[176:179], v[128:131]
    s_nop 1
    v_mfma_f32_16x16x32_bf16 v[128:131], v[212:215], v[180:183], v[128:131]
    s_add_u32 s99, s62, 262144
    s_nop 6
    ds_write_b128 v12, v[128:131] offset:14848

    s_waitcnt lgkmcnt(0)
    s_cbranch_execz G_105
    s_barrier
G_105:
    ds_read2st64_b32 v[52:53], v35 offset0:58 offset1:60
    ds_read2st64_b32 v[54:55], v35 offset0:62 offset1:64
    s_cmp_ge_u32 s3, 2
    s_waitcnt lgkmcnt(0)
    v_add_f32 v52, v52, v53
    v_add_f32 v54, v54, v55
    v_add_f32 v52, v52, v54
    v_add_u32 v52, v52, v11
    v_bfi_b32 v52, s70, v10, v52

    s_cbranch_execz LtW_ret
    s_mov_b32 s71, 1
    s_cbranch_scc1 R_p
    buffer_store_dword v52, v13, s[40:43], s62 offen
    buffer_load_dwordx4 v[216:219], v40, s[40:43], s55 offen sc1
    buffer_load_dwordx4 v[224:227], v41, s[40:43], s55 offen sc1
    buffer_store_dword v52, v13, s[40:43], s99 offen sc1

    s_waitcnt vmcnt(1)
    s_branch R_c

LtSEG3:
    s_mov_b32 s71, 0
R_p:
    s_add_u32 s71, s71, 1
    s_and_b32 s96, s71, 63
    s_cmp_eq_u32 s96, 0
    s_cselect_b32 s96, s54, s55

    s_cbranch_execz G_106
    buffer_load_dwordx4 v[216:219], v40, s[40:43], s96 offen sc1
    buffer_load_dwordx4 v[224:227], v41, s[40:43], s96 offen sc1
    s_waitcnt vmcnt(0)

G_106:
R_c:
    v_msad_u8 v58, v216, s28, 0
    v_msad_u8 v59, v217, s29, 0
    v_msad_u8 v58, v218, s30, v58
    v_msad_u8 v59, v219, s31, v59
    v_msad_u8 v58, v224, s28, v58
    v_msad_u8 v59, v225, s29, v59
    v_msad_u8 v58, v226, s30, v58
    v_msad_u8 v59, v227, s31, v59
    v_or_b32 v58, v58, v59
    v_cmp_ne_u32 vcc, 0, v58
    s_cmp_eq_u32 s71, 1048576
    s_cbranch_scc1 R_ok
    s_cbranch_vccnz R_p
R_ok:

    v_mul_f32 v224, v224, v42
    v_mul_f32 v225, v225, v42
    v_mul_f32 v226, v226, v42
    v_mul_f32 v227, v227, v42
    v_permlane32_swap_b32 v216, v218
    v_permlane32_swap_b32 v217, v219
    v_permlane32_swap_b32 v224, v226
    v_permlane32_swap_b32 v225, v227
    v_add_f32 v216, v216, v218
    v_add_f32 v217, v217, v219
    v_add_f32 v224, v224, v226
    v_add_f32 v225, v225, v227
    v_lshlrev_b32 v43, 16, v43
    v_permlane16_swap_b32 v216, v217
    v_permlane16_swap_b32 v224, v225
    v_add_f32 v216, v216, v217
    v_add_f32 v224, v224, v225
    s_nop 0
    v_add_f32_dpp v216, v216, v216 row_ror:8 row_mask:0xf bank_mask:0xf
    v_add_f32_dpp v224, v224, v224 row_ror:8 row_mask:0xf bank_mask:0xf

    s_nop 0
    v_add_f32_dpp v216, v216, v216 row_ror:4 row_mask:0xf bank_mask:0xf
    v_add_f32_dpp v224, v224, v224 row_ror:4 row_mask:0xf bank_mask:0xf
    s_nop 0
    v_add_f32_dpp v216, v216, v216 row_ror:2 row_mask:0xf bank_mask:0xf
    v_add_f32_dpp v224, v224, v224 row_ror:2 row_mask:0xf bank_mask:0xf
    v_cvt_pk_bf16_f32 v216, v216, v224
    v_lshlrev_b32 v224, 16, v216
    v_and_b32 v216, 0xffff0000, v216
    v_add_f32 v224, v224, v43
    v_cvt_pk_bf16_f32 v224, v224, v224
    v_and_b32 v224, 0xffff0000, v224
    v_add_f32 v216, v216, v224
    v_cvt_pk_bf16_f32 v216, v216, v216

    s_cbranch_execz LtW_ret
    s_mov_b64 exec, s[56:57]
    buffer_store_short v216, v44, s[16:19], 0 offen
    s_or_b32 s96, s65, s3
    s_cmp_lg_u32 s96, 0
    s_cbranch_scc1 R_done
    v_mov_b32 v224, s35
    v_mov_b32 v225, 0
    s_mov_b64 exec, 1
    buffer_store_dword v224, v225, s[40:43], 0 offen offset:0

R_done:
    s_mov_b64 exec, -1

L_end:
    s_endpgm
L_code_end:

.section .rodata,"a"
.p2align 6
.amdhsa_kernel parallel_sum__sliding_block_cached__swiglu_ffn__decode_kernel
  .amdhsa_next_free_vgpr 332
  .amdhsa_next_free_sgpr 102
  .amdhsa_accum_offset 236
  .amdhsa_group_segment_fixed_size 0
  .amdhsa_kernarg_size 96
  .amdhsa_user_sgpr_count 2
  .amdhsa_user_sgpr_kernarg_segment_ptr 1
  .amdhsa_system_sgpr_workgroup_id_x 1
.end_amdhsa_kernel
```
